```python
import torch

def _softmax(x, axis=-1):
    return torch.softmax(x, dim=axis)

def _gelu(x):
    return torch.nn.functional.gelu(x, approximate='tanh')

def _silu(x):
    return torch.nn.functional.silu(x)

def _sigmoid(x):
    return torch.sigmoid(x)

def _layernorm(x, axis=-1, eps=1e-05):
    m = x.mean(dim=axis, keepdim=True)
    v = x.var(dim=axis, keepdim=True, unbiased=False)
    return (x - m) / torch.sqrt(v + eps)

def _scatter_add(tgt, idx, src, axis=0):
    return tgt.clone().index_add_(axis, idx, src)

def _segment_sum(src, seg, n):
    out = torch.zeros((n,) + src.shape[1:], dtype=src.dtype)
    return out.index_add_(0, seg, src)

def _pad(x, pw):
    flat = tuple((v for pair in reversed(pw) for v in pair))
    return torch.nn.functional.pad(x, flat)
kernel_name = 'standalone__conformer_conv_module__speech'

def setup_inputs():

    _w = lambda a: (lambda t: t.to(torch.bfloat16) if t.is_floating_point() else t)(torch.as_tensor(a))
    B, T, D, K = (2, 4000, 512, 15)
    return {'x': _w((lambda *s: torch.randn(*s, dtype=torch.bfloat16) * 0.2)(B, T, D)), 'w_pw1': _w((lambda *s: torch.randn(*s, dtype=torch.bfloat16) * 0.2)(D, 2 * D)), 'dw': _w((lambda *s: torch.randn(*s, dtype=torch.bfloat16) * 0.2)(K, D)), 'w_pw2': _w((lambda *s: torch.randn(*s, dtype=torch.bfloat16) * 0.05)(D, D))}

def reference(x, w_pw1, dw, w_pw2):
    B, T, D = x.shape
    K = dw.shape[0]
    h = x @ w_pw1
    a, b = (h[..., :D].clone(), h[..., D:].clone())
    h = a * _sigmoid(b)
    pad = K // 2
    hp = _pad(h, ((0, 0), (pad, pad), (0, 0)))
    out = torch.zeros_like(h)
    for i in range(K):
        out = out + hp[:, i:i + T, :] * dw[i][None, None, :]
    return _silu(out) @ w_pw2
```

```asm
; @launch grid=(256,1,1) block=(768,1,1) lds=163840
.amdgcn_target "amdgcn-amd-amdhsa--gfx950"
.text
.globl standalone__conformer_conv_module__speech_kernel
.p2align 8
.type standalone__conformer_conv_module__speech_kernel,@function
standalone__conformer_conv_module__speech_kernel:
    s_cmp_ge_u32 s2, 256
    s_cbranch_scc1 L_end
    s_load_dwordx8 s[4:11], s[0:1], 0
    s_load_dwordx4 s[12:15], s[0:1], 32
    s_load_dwordx2 s[16:17], s[0:1], 48
    s_memrealtime s[70:71]
    v_lshrrev_b32 v2, 6, v0
    v_and_b32 v1, 63, v0
    v_readfirstlane_b32 s48, v2
    s_and_b32 s66, s2, 7
    s_lshr_b32 s67, s2, 3
    s_and_b32 s52, s67, 7
    s_lshr_b32 s67, s67, 3
    s_lshl_b32 s51, s66, 2
    s_add_u32 s51, s51, s67
    s_and_b32 s53, s51, 15
    s_lshr_b32 s54, s51, 4
    s_lshl_b32 s67, s67, 1
    s_mul_i32 s55, s52, 0
    s_add_u32 s55, s55, s67
    s_and_b32 s49, s48, 3
    s_mul_i32 s3, s54, 4096000
    s_cmp_ge_u32 s48, 8
    s_cbranch_scc1 L_loader
    s_lshr_b32 s50, s48, 2
    v_lshrrev_b32 v32, 2, v1
    v_and_b32 v33, 3, v1
    v_bfe_u32 v35, v1, 4, 1
    v_lshrrev_b32 v36, 5, v1
    v_bfe_u32 v37, v1, 2, 2
    v_lshl_add_u32 v34, v36, 3, v37
    v_lshlrev_b32 v40, 8, v34
    v_lshrrev_b32 v43, 4, v1
    v_lshl_add_u32 v44, v43, 3, v37
    v_lshlrev_b32 v44, 8, v44
    v_lshrrev_b32 v38, 1, v33
    s_lshl_b32 s67, s49, 1
    v_add_u32 v38, s67, v38
    v_lshlrev_b32 v39, 1, v37
    v_xor_b32 v38, v38, v39
    v_lshl_add_u32 v38, v38, 4, v44
    v_lshl_add_u32 v38, v35, 7, v38
    v_and_b32 v39, 1, v33
    v_lshl_add_u32 v12, v39, 3, v38
    v_xor_b32 v10, 0x80, v12
    v_xor_b32 v38, s49, v37
    v_lshl_add_u32 v38, v38, 6, v40
    v_lshl_add_u32 v38, v39, 5, v38
    v_lshl_add_u32 v38, v35, 4, v38
    v_lshrrev_b32 v39, 1, v33
    v_lshl_add_u32 v5, v39, 3, v38
    v_add_u32 v6, 0x10000, v5
    v_and_b32 v41, 31, v1
    v_and_b32 v42, 15, v1
    v_bfe_u32 v38, v42, 1, 3
    v_xor_b32 v38, v38, v43
    s_lshl_b32 s67, s50, 14
    s_add_u32 s67, s67, 16384
    v_lshl_add_u32 v40, v42, 7, s67
    v_xor_b32 v39, 0, v38
    v_lshl_add_u32 v8, v39, 4, v40
    v_xor_b32 v39, 4, v38
    v_lshl_add_u32 v9, v39, 4, v40
    s_lshl_b32 s66, s52, 7
    s_lshl_b32 s67, s49, 5
    s_add_u32 s66, s66, s67
    s_sub_u32 s66, s66, 3072
    v_lshrrev_b32 v40, 1, v1
    v_lshl_add_u32 v40, v40, 10, s66
    v_and_b32 v38, 1, v1
    v_lshl_add_u32 v45, v38, 4, v40
    s_lshl_b32 s68, s48, 10
    s_add_u32 m0, s68, 147456
    s_add_u32 s68, s68, 147552
    s_mov_b32 s42, 15360
    s_mov_b32 s43, 0x00020000
    s_waitcnt lgkmcnt(0)
    s_mov_b32 s40, s8
    s_mov_b32 s41, s9
    buffer_load_dwordx4 v45, s[40:43], 0 offen lds
    v_lshl_add_u32 v40, v32, 1, s68
    v_lshlrev_b32 v38, 5, v33
    v_sub_u32 v22, v40, v38
    s_lshl_b32 s67, s49, 10
    s_mul_i32 s66, s48, 2560
    s_add_u32 s66, s66, 139264
    v_mul_u32_u24 v40, 160, v32
    v_lshl_add_u32 v40, v33, 4, v40
    v_add_u32 v15, s66, v40
    v_subrev_u32 v38, 128, v15
    s_add_u32 s67, s67, 159616
    v_lshl_add_u32 v39, v32, 5, s67
    v_lshl_add_u32 v39, v33, 4, v39
    s_cmp_eq_u32 s50, 1
    s_cselect_b64 vcc, -1, 0
    v_cndmask_b32 v39, v15, v39, vcc
    v_cmp_eq_u32 vcc, 3, v33
    s_nop 1
    v_cndmask_b32 v16, v15, v38, vcc
    v_cndmask_b32 v18, v15, v39, vcc
    v_cmp_lt_u32 vcc, 1, v33
    s_nop 1
    v_cndmask_b32 v17, v15, v38, vcc
    v_cndmask_b32 v19, v15, v39, vcc
    v_mul_u32_u24 v40, 160, v42
    v_lshlrev_b32 v38, 3, v43
    v_add_u32 v40, v40, v38
    v_add_u32 v13, s66, v40
    s_sub_u32 s67, s66, 10112
    v_add_u32 v40, s67, v40
    v_lshl_add_u32 v38, v42, 5, v38
    s_cmp_eq_u32 s50, 1
    s_cselect_b64 vcc, -1, 0
    v_cndmask_b32 v14, v38, v40, vcc
    s_lshl_b32 s66, s48, 10
    s_add_u32 s66, s66, 131072
    v_lshlrev_b32 v40, 6, v34
    v_lshl_add_u32 v40, v35, 5, v40
    v_lshl_add_u32 v40, v33, 3, v40
    v_add_u32 v20, s66, v40
    v_lshl_add_u32 v11, v1, 4, s66
    s_lshr_b32 s67, s52, 1
    s_lshl_b32 s67, s67, 8
    s_lshl_b32 s66, s49, 6
    s_add_u32 s67, s67, s66
    s_and_b32 s66, s52, 1
    s_lshl_b32 s68, s66, 17
    s_add_u32 s67, s67, s68
    s_lshl_b32 s68, s53, 18
    s_add_u32 s67, s67, s68
    s_lshl_b32 s68, s50, 15
    s_add_u32 s67, s67, s68
    v_lshl_add_u32 v40, v41, 10, s67
    v_lshl_add_u32 v3, v36, 5, v40
    v_lshlrev_b32 v21, 4, v1
    s_cmp_eq_u32 s50, 0
    s_cselect_b32 s67, 98304, 0
    v_add_u32 v2, s67, v21
    s_lshl_b32 s82, 32768, s50
    s_lshl_b32 s67, s52, 2
    s_add_u32 s67, s67, s49
    s_lshl_b32 s68, s51, 3
    s_lshl_b32 s69, s50, 2
    s_add_u32 s69, s69, s68
    s_and_b32 s72, s69, 127
    s_lshl_b32 s72, s72, 5
    s_add_u32 s72, s72, s67
    s_lshl_b32 s72, s72, 10
    s_lshl_b32 s73, s69, 3
    s_add_u32 s73, s73, s52
    s_lshl_b32 s73, s73, 7
    s_lshl_b32 s69, s49, 3
    s_add_u32 s73, s73, s69
    s_add_u32 s73, s73, 9437184
    s_lshl_b32 s69, s51, 5
    s_add_u32 s69, s69, s67
    s_lshl_b32 s74, s69, 9
    s_add_u32 s74, s74, 8388608
    s_lshl_b32 s75, s69, 7
    s_add_u32 s75, s75, 10485760
    s_mov_b32 s83, 0xbfb8aa3b
    v_mov_b32 v40, 0x80000000
    v_cmp_eq_u32 vcc, 0, v1
    s_nop 1
    v_cndmask_b32 v4, v40, v1, vcc
    s_waitcnt lgkmcnt(0)
    s_mov_b32 s32, s16
    s_mov_b32 s33, s17
    s_mov_b32 s34, 16777216
    s_mov_b32 s35, 0x00020000
    s_mov_b32 s44, s14
    s_mov_b32 s45, s15
    s_mov_b32 s46, 256
    s_mov_b32 s47, 0x00020000
    s_add_u32 s36, s12, s3
    s_addc_u32 s37, s13, 0
    s_mov_b32 s38, 4096000
    s_mov_b32 s39, 0x00020000
    s_mov_b32 s28, s10
    s_mov_b32 s29, s11
    s_mov_b32 s30, 524288
    s_mov_b32 s31, 0x00020000
    s_or_b32 s70, s70, 1
    s_lshl_b32 s71, s2, 10
    v_add_u32 v38, s71, v0
    v_cmp_eq_u32 vcc, 0, v38
    s_nop 1
    v_cndmask_b32 v38, v40, v38, vcc
    v_mov_b32 v39, s70
    buffer_store_dword v39, v38, s[44:47], 0 offen sc1
    s_cmp_eq_u32 s50, 1
    s_cselect_b64 vcc, -1, 0
    s_mov_b32 s22, 4096000
    s_mov_b32 s23, 0x00020000
    s_add_u32 s20, s4, s3
    s_addc_u32 s21, s5, 0
    s_lshl_b32 s66, s48, 1
    s_add_u32 s66, s66, s55
    s_add_u32 s66, s66, 2
    s_and_b32 s66, s66, 7
    s_lshl_b32 s88, s66, 7
    s_lshl_b32 s67, s53, 8
    s_lshl_b32 s68, s52, 5
    s_add_u32 s67, s67, s68
    s_sub_u32 s67, s67, 7
    v_lshrrev_b32 v26, 1, v1
    v_add_u32 v26, s67, v26
    v_lshlrev_b32 v27, 10, v26
    v_and_b32 v28, 1, v1
    v_lshl_add_u32 v27, v28, 7, v27
    v_mov_b32 v29, 0x80000000
    v_cmp_gt_i32 s[84:85], 0, v26
    s_nop 1
    v_cndmask_b32 v23, v27, v29, s[84:85]
    s_waitcnt vmcnt(1)
    ds_read_u16 v48, v22 offset:0
    ds_read_u16 v49, v22 offset:32
    ds_read_u16 v50, v22 offset:64
    ds_read_u16 v51, v22 offset:96
    ds_read_u16 v52, v22 offset:128
    ds_read_u16 v53, v22 offset:160
    ds_read_u16 v54, v22 offset:192
    ds_read_u16 v55, v22 offset:224
    ds_read_u16 v56, v22 offset:256
    ds_read_u16 v57, v22 offset:288
    ds_read_u16 v58, v22 offset:320
    ds_read_u16 v59, v22 offset:352
    ds_read_u16 v60, v22 offset:384
    ds_read_u16 v61, v22 offset:416
    ds_read_u16 v62, v22 offset:448
    ds_read_u16 v63, v22 offset:480
    ds_read_u16 v64, v22 offset:512
    ds_read_u16 v65, v22 offset:544
    ds_read_u16 v66, v22 offset:576
    ds_read_u16 v67, v22 offset:608
    s_waitcnt lgkmcnt(15)
    v_lshl_or_b32 v96, v49, 16, v48
    v_lshl_or_b32 v97, v51, 16, v50
    s_waitcnt lgkmcnt(14)
    v_lshl_or_b32 v98, v53, 16, v52
    s_waitcnt lgkmcnt(12)
    v_lshl_or_b32 v99, v55, 16, v54
    s_waitcnt lgkmcnt(10)
    v_lshl_or_b32 v100, v57, 16, v56
    s_waitcnt lgkmcnt(8)
    v_lshl_or_b32 v101, v59, 16, v58
    s_waitcnt lgkmcnt(6)
    v_lshl_or_b32 v102, v61, 16, v60
    s_waitcnt lgkmcnt(4)
    v_lshl_or_b32 v103, v63, 16, v62
    s_waitcnt lgkmcnt(2)
    v_lshl_or_b32 v30, v65, 16, v64
    s_waitcnt lgkmcnt(0)
    v_lshl_or_b32 v31, v67, 16, v66
    s_barrier
    ds_read_b64_tr_b16 a[32:33], v12 offset:0
    ds_read_b64_tr_b16 a[34:35], v12 offset:1024
    ds_read_b64_tr_b16 a[36:37], v10 offset:0
    ds_read_b64_tr_b16 a[38:39], v10 offset:1024
    ds_read_b128 a[0:3], v8 offset:0
    ds_read_b128 a[4:7], v8 offset:2048
    ds_read_b64_tr_b16 a[40:41], v12 offset:8192
    ds_read_b64_tr_b16 a[42:43], v12 offset:9216
    ds_read_b64_tr_b16 a[44:45], v10 offset:8192
    ds_read_b64_tr_b16 a[46:47], v10 offset:9216
    ds_read_b128 a[8:11], v8 offset:4096
    ds_read_b128 a[12:15], v8 offset:6144
    ds_read_b128 a[16:19], v8 offset:8192
    ds_read_b128 a[20:23], v8 offset:10240
    ds_read_b128 a[24:27], v8 offset:12288
    ds_read_b128 a[28:31], v8 offset:14336
    s_waitcnt lgkmcnt(10)
    v_mfma_f32_16x16x32_bf16 v[32:35], a[0:3], a[32:35], 0
    v_mfma_f32_16x16x32_bf16 v[36:39], a[0:3], a[36:39], 0
    ds_read_b128 a[0:3], v9 offset:0
    s_cmp_eq_u32 s48, 1
    s_cselect_b32 s66, s88, 4096000
    buffer_load_dword v0, v23, s[20:23], s66 offen
    v_mfma_f32_16x16x32_bf16 v[40:43], a[4:7], a[32:35], 0
    v_mfma_f32_16x16x32_bf16 v[44:47], a[4:7], a[36:39], 0
    ds_read_b128 a[4:7], v9 offset:2048
    s_waitcnt lgkmcnt(6)
    v_mfma_f32_16x16x32_bf16 v[48:51], a[8:11], a[32:35], 0
    v_mfma_f32_16x16x32_bf16 v[52:55], a[8:11], a[36:39], 0
    ds_read_b128 a[8:11], v9 offset:4096
    v_mfma_f32_16x16x32_bf16 v[56:59], a[12:15], a[32:35], 0
    v_mfma_f32_16x16x32_bf16 v[60:63], a[12:15], a[36:39], 0
    ds_read_b128 a[12:15], v9 offset:6144
    s_waitcnt lgkmcnt(6)
    v_mfma_f32_16x16x32_bf16 v[64:67], a[16:19], a[32:35], 0
    v_mfma_f32_16x16x32_bf16 v[68:71], a[16:19], a[36:39], 0
    ds_read_b128 a[16:19], v9 offset:8192
    v_mfma_f32_16x16x32_bf16 v[72:75], a[20:23], a[32:35], 0
    v_mfma_f32_16x16x32_bf16 v[76:79], a[20:23], a[36:39], 0
    ds_read_b128 a[20:23], v9 offset:10240
    s_waitcnt lgkmcnt(6)
    v_mfma_f32_16x16x32_bf16 v[80:83], a[24:27], a[32:35], 0
    v_mfma_f32_16x16x32_bf16 v[84:87], a[24:27], a[36:39], 0
    ds_read_b128 a[24:27], v9 offset:12288
    v_mfma_f32_16x16x32_bf16 v[88:91], a[28:31], a[32:35], 0
    v_mfma_f32_16x16x32_bf16 v[92:95], a[28:31], a[36:39], 0
    ds_read_b128 a[28:31], v9 offset:14336
    s_waitcnt lgkmcnt(6)
    v_mfma_f32_16x16x32_bf16 v[32:35], a[0:3], a[40:43], v[32:35]
    v_mfma_f32_16x16x32_bf16 v[36:39], a[0:3], a[44:47], v[36:39]
    v_add_u32 v12, 0xc000, v12
    v_add_u32 v10, 0xc000, v10
    v_add_u32 v8, 0xc000, v8
    v_add_u32 v9, 0xc000, v9
    v_mfma_f32_16x16x32_bf16 v[40:43], a[4:7], a[40:43], v[40:43]
    v_mfma_f32_16x16x32_bf16 v[44:47], a[4:7], a[44:47], v[44:47]
    s_waitcnt lgkmcnt(4)
    v_mfma_f32_16x16x32_bf16 v[48:51], a[8:11], a[40:43], v[48:51]
    v_mfma_f32_16x16x32_bf16 v[52:55], a[8:11], a[44:47], v[52:55]
    v_mfma_f32_16x16x32_bf16 v[56:59], a[12:15], a[40:43], v[56:59]
    v_mfma_f32_16x16x32_bf16 v[60:63], a[12:15], a[44:47], v[60:63]
    s_waitcnt lgkmcnt(0)
    s_barrier
    v_mfma_f32_16x16x32_bf16 v[64:67], a[16:19], a[40:43], v[64:67]
    v_mfma_f32_16x16x32_bf16 v[68:71], a[16:19], a[44:47], v[68:71]
    ds_read_b64_tr_b16 a[48:49], v12 offset:0
    ds_read_b64_tr_b16 a[50:51], v12 offset:1024
    ds_read_b64_tr_b16 a[52:53], v10 offset:0
    ds_read_b64_tr_b16 a[54:55], v10 offset:1024
    ds_read_b128 a[0:3], v8 offset:0
    ds_read_b128 a[4:7], v8 offset:2048
    v_mfma_f32_16x16x32_bf16 v[72:75], a[20:23], a[40:43], v[72:75]
    v_mfma_f32_16x16x32_bf16 v[76:79], a[20:23], a[44:47], v[76:79]
    ds_read_b64_tr_b16 a[32:33], v12 offset:8192
    ds_read_b64_tr_b16 a[34:35], v12 offset:9216
    ds_read_b64_tr_b16 a[36:37], v10 offset:8192
    ds_read_b64_tr_b16 a[38:39], v10 offset:9216
    ds_read_b128 a[8:11], v8 offset:4096
    ds_read_b128 a[12:15], v8 offset:6144
    ds_read_b128 a[16:19], v8 offset:8192
    v_mfma_f32_16x16x32_bf16 v[80:83], a[24:27], a[40:43], v[80:83]
    v_mfma_f32_16x16x32_bf16 v[84:87], a[24:27], a[44:47], v[84:87]
    ds_read_b128 a[20:23], v8 offset:10240
    ds_read_b128 a[24:27], v8 offset:12288
    v_mfma_f32_16x16x32_bf16 v[88:91], a[28:31], a[40:43], v[88:91]
    v_mfma_f32_16x16x32_bf16 v[92:95], a[28:31], a[44:47], v[92:95]
    ds_read_b128 a[28:31], v8 offset:14336
    s_waitcnt lgkmcnt(10)
    v_mfma_f32_16x16x32_bf16 v[32:35], a[0:3], a[48:51], v[32:35]
    v_mfma_f32_16x16x32_bf16 v[36:39], a[0:3], a[52:55], v[36:39]
    ds_read_b128 a[0:3], v9 offset:0
    s_cmp_eq_u32 s48, 2
    s_cselect_b32 s66, s88, 4096000
    buffer_load_dword v0, v23, s[20:23], s66 offen
    v_mfma_f32_16x16x32_bf16 v[40:43], a[4:7], a[48:51], v[40:43]
    v_mfma_f32_16x16x32_bf16 v[44:47], a[4:7], a[52:55], v[44:47]
    ds_read_b128 a[4:7], v9 offset:2048
    s_waitcnt lgkmcnt(6)
    v_mfma_f32_16x16x32_bf16 v[48:51], a[8:11], a[48:51], v[48:51]
    v_mfma_f32_16x16x32_bf16 v[52:55], a[8:11], a[52:55], v[52:55]
    ds_read_b128 a[8:11], v9 offset:4096
    v_mfma_f32_16x16x32_bf16 v[56:59], a[12:15], a[48:51], v[56:59]
    v_mfma_f32_16x16x32_bf16 v[60:63], a[12:15], a[52:55], v[60:63]
    ds_read_b128 a[12:15], v9 offset:6144
    s_waitcnt lgkmcnt(6)
    v_mfma_f32_16x16x32_bf16 v[64:67], a[16:19], a[48:51], v[64:67]
    v_mfma_f32_16x16x32_bf16 v[68:71], a[16:19], a[52:55], v[68:71]
    ds_read_b128 a[16:19], v9 offset:8192
    v_mfma_f32_16x16x32_bf16 v[72:75], a[20:23], a[48:51], v[72:75]
    v_mfma_f32_16x16x32_bf16 v[76:79], a[20:23], a[52:55], v[76:79]
    ds_read_b128 a[20:23], v9 offset:10240
    s_waitcnt lgkmcnt(6)
    v_mfma_f32_16x16x32_bf16 v[80:83], a[24:27], a[48:51], v[80:83]
    v_mfma_f32_16x16x32_bf16 v[84:87], a[24:27], a[52:55], v[84:87]
    ds_read_b128 a[24:27], v9 offset:12288
    v_mfma_f32_16x16x32_bf16 v[88:91], a[28:31], a[48:51], v[88:91]
    v_mfma_f32_16x16x32_bf16 v[92:95], a[28:31], a[52:55], v[92:95]
    ds_read_b128 a[28:31], v9 offset:14336
    s_waitcnt lgkmcnt(6)
    v_mfma_f32_16x16x32_bf16 v[32:35], a[0:3], a[32:35], v[32:35]
    v_mfma_f32_16x16x32_bf16 v[36:39], a[0:3], a[36:39], v[36:39]
    v_add_u32 v12, 0xc000, v12
    v_add_u32 v10, 0xc000, v10
    v_add_u32 v8, 0xc000, v8
    v_add_u32 v9, 0xc000, v9
    v_mfma_f32_16x16x32_bf16 v[40:43], a[4:7], a[32:35], v[40:43]
    v_mfma_f32_16x16x32_bf16 v[44:47], a[4:7], a[36:39], v[44:47]
    s_waitcnt lgkmcnt(4)
    v_mfma_f32_16x16x32_bf16 v[48:51], a[8:11], a[32:35], v[48:51]
    v_mfma_f32_16x16x32_bf16 v[52:55], a[8:11], a[36:39], v[52:55]
    v_mfma_f32_16x16x32_bf16 v[56:59], a[12:15], a[32:35], v[56:59]
    v_mfma_f32_16x16x32_bf16 v[60:63], a[12:15], a[36:39], v[60:63]
    s_waitcnt lgkmcnt(0)
    s_barrier
    v_mfma_f32_16x16x32_bf16 v[64:67], a[16:19], a[32:35], v[64:67]
    v_mfma_f32_16x16x32_bf16 v[68:71], a[16:19], a[36:39], v[68:71]
    ds_read_b64_tr_b16 a[40:41], v12 offset:0
    ds_read_b64_tr_b16 a[42:43], v12 offset:1024
    ds_read_b64_tr_b16 a[44:45], v10 offset:0
    ds_read_b64_tr_b16 a[46:47], v10 offset:1024
    ds_read_b128 a[0:3], v8 offset:0
    ds_read_b128 a[4:7], v8 offset:2048
    v_mfma_f32_16x16x32_bf16 v[72:75], a[20:23], a[32:35], v[72:75]
    v_mfma_f32_16x16x32_bf16 v[76:79], a[20:23], a[36:39], v[76:79]
    ds_read_b64_tr_b16 a[48:49], v12 offset:8192
    ds_read_b64_tr_b16 a[50:51], v12 offset:9216
    ds_read_b64_tr_b16 a[52:53], v10 offset:8192
    ds_read_b64_tr_b16 a[54:55], v10 offset:9216
    ds_read_b128 a[8:11], v8 offset:4096
    ds_read_b128 a[12:15], v8 offset:6144
    ds_read_b128 a[16:19], v8 offset:8192
    v_mfma_f32_16x16x32_bf16 v[80:83], a[24:27], a[32:35], v[80:83]
    v_mfma_f32_16x16x32_bf16 v[84:87], a[24:27], a[36:39], v[84:87]
    ds_read_b128 a[20:23], v8 offset:10240
    ds_read_b128 a[24:27], v8 offset:12288
    v_mfma_f32_16x16x32_bf16 v[88:91], a[28:31], a[32:35], v[88:91]
    v_mfma_f32_16x16x32_bf16 v[92:95], a[28:31], a[36:39], v[92:95]
    ds_read_b128 a[28:31], v8 offset:14336
    s_waitcnt lgkmcnt(10)
    v_mfma_f32_16x16x32_bf16 v[32:35], a[0:3], a[40:43], v[32:35]
    v_mfma_f32_16x16x32_bf16 v[36:39], a[0:3], a[44:47], v[36:39]
    ds_read_b128 a[0:3], v9 offset:0
    v_and_b32 v26, 7, v1
    v_lshrrev_b32 v27, 3, v1
    v_mov_b32 v29, 0x80000000
    v_lshlrev_b32 v28, 10, v1
    v_cmp_gt_u32 s[84:85], 4, v1
    s_nop 1
    v_cndmask_b32 v28, v29, v28, s[84:85]
    buffer_load_dword v0, v28, s[32:35], s73 offen
    s_and_b32 s66, s51, 3
    s_lshl_b32 s66, s66, 1
    s_and_b32 s67, s52, 1
    s_add_u32 s66, s66, s67
    s_lshl_b32 s66, s66, 3
    s_add_u32 s66, s66, s48
    s_lshl_b32 s66, s66, 13
    s_lshr_b32 s67, s52, 1
    s_lshl_b32 s67, s67, 8
    s_add_u32 s66, s66, s67
    v_lshlrev_b32 v28, 10, v26
    v_lshl_add_u32 v28, v27, 7, v28
    v_cmp_gt_u32 s[84:85], 16, v1
    s_nop 1
    v_cndmask_b32 v28, v29, v28, s[84:85]
    buffer_load_dword v0, v28, s[28:31], s66 offen
    v_mfma_f32_16x16x32_bf16 v[40:43], a[4:7], a[40:43], v[40:43]
    v_mfma_f32_16x16x32_bf16 v[44:47], a[4:7], a[44:47], v[44:47]
    ds_read_b128 a[4:7], v9 offset:2048
    s_waitcnt lgkmcnt(6)
    v_mfma_f32_16x16x32_bf16 v[48:51], a[8:11], a[40:43], v[48:51]
    v_mfma_f32_16x16x32_bf16 v[52:55], a[8:11], a[44:47], v[52:55]
    ds_read_b128 a[8:11], v9 offset:4096
    v_mfma_f32_16x16x32_bf16 v[56:59], a[12:15], a[40:43], v[56:59]
    v_mfma_f32_16x16x32_bf16 v[60:63], a[12:15], a[44:47], v[60:63]
    ds_read_b128 a[12:15], v9 offset:6144
    s_waitcnt lgkmcnt(6)
    v_mfma_f32_16x16x32_bf16 v[64:67], a[16:19], a[40:43], v[64:67]
    v_mfma_f32_16x16x32_bf16 v[68:71], a[16:19], a[44:47], v[68:71]
    ds_read_b128 a[16:19], v9 offset:8192
    v_mfma_f32_16x16x32_bf16 v[72:75], a[20:23], a[40:43], v[72:75]
    v_mfma_f32_16x16x32_bf16 v[76:79], a[20:23], a[44:47], v[76:79]
    ds_read_b128 a[20:23], v9 offset:10240
    s_waitcnt lgkmcnt(6)
    v_mfma_f32_16x16x32_bf16 v[80:83], a[24:27], a[40:43], v[80:83]
    v_mfma_f32_16x16x32_bf16 v[84:87], a[24:27], a[44:47], v[84:87]
    ds_read_b128 a[24:27], v9 offset:12288
    v_mfma_f32_16x16x32_bf16 v[88:91], a[28:31], a[40:43], v[88:91]
    v_mfma_f32_16x16x32_bf16 v[92:95], a[28:31], a[44:47], v[92:95]
    ds_read_b128 a[28:31], v9 offset:14336
    s_waitcnt lgkmcnt(6)
    v_mfma_f32_16x16x32_bf16 v[32:35], a[0:3], a[48:51], v[32:35]
    v_mfma_f32_16x16x32_bf16 v[36:39], a[0:3], a[52:55], v[36:39]
    v_add_u32 v12, 0xfffe8000, v12
    v_add_u32 v10, 0xfffe8000, v10
    v_add_u32 v8, 0xfffe8000, v8
    v_add_u32 v9, 0xfffe8000, v9
    v_mfma_f32_16x16x32_bf16 v[40:43], a[4:7], a[48:51], v[40:43]
    v_mfma_f32_16x16x32_bf16 v[44:47], a[4:7], a[52:55], v[44:47]
    s_waitcnt lgkmcnt(4)
    v_mfma_f32_16x16x32_bf16 v[48:51], a[8:11], a[48:51], v[48:51]
    v_mfma_f32_16x16x32_bf16 v[52:55], a[8:11], a[52:55], v[52:55]
    v_mfma_f32_16x16x32_bf16 v[56:59], a[12:15], a[48:51], v[56:59]
    v_mfma_f32_16x16x32_bf16 v[60:63], a[12:15], a[52:55], v[60:63]
    s_waitcnt lgkmcnt(0)
    s_barrier
    v_mfma_f32_16x16x32_bf16 v[64:67], a[16:19], a[48:51], v[64:67]
    v_mfma_f32_16x16x32_bf16 v[68:71], a[16:19], a[52:55], v[68:71]
    ds_read_b64_tr_b16 a[32:33], v12 offset:0
    ds_read_b64_tr_b16 a[34:35], v12 offset:1024
    ds_read_b64_tr_b16 a[36:37], v10 offset:0
    ds_read_b64_tr_b16 a[38:39], v10 offset:1024
    ds_read_b128 a[0:3], v8 offset:0
    ds_read_b128 a[4:7], v8 offset:2048
    v_mfma_f32_16x16x32_bf16 v[72:75], a[20:23], a[48:51], v[72:75]
    v_mfma_f32_16x16x32_bf16 v[76:79], a[20:23], a[52:55], v[76:79]
    ds_read_b64_tr_b16 a[40:41], v12 offset:8192
    ds_read_b64_tr_b16 a[42:43], v12 offset:9216
    ds_read_b64_tr_b16 a[44:45], v10 offset:8192
    ds_read_b64_tr_b16 a[46:47], v10 offset:9216
    ds_read_b128 a[8:11], v8 offset:4096
    ds_read_b128 a[12:15], v8 offset:6144
    ds_read_b128 a[16:19], v8 offset:8192
    v_mfma_f32_16x16x32_bf16 v[80:83], a[24:27], a[48:51], v[80:83]
    v_mfma_f32_16x16x32_bf16 v[84:87], a[24:27], a[52:55], v[84:87]
    ds_read_b128 a[20:23], v8 offset:10240
    ds_read_b128 a[24:27], v8 offset:12288
    v_mfma_f32_16x16x32_bf16 v[88:91], a[28:31], a[48:51], v[88:91]
    v_mfma_f32_16x16x32_bf16 v[92:95], a[28:31], a[52:55], v[92:95]
    ds_read_b128 a[28:31], v8 offset:14336
    s_waitcnt lgkmcnt(10)
    v_mfma_f32_16x16x32_bf16 v[32:35], a[0:3], a[32:35], v[32:35]
    v_mfma_f32_16x16x32_bf16 v[36:39], a[0:3], a[36:39], v[36:39]
    ds_read_b128 a[0:3], v9 offset:0
    v_mfma_f32_16x16x32_bf16 v[40:43], a[4:7], a[32:35], v[40:43]
    v_mfma_f32_16x16x32_bf16 v[44:47], a[4:7], a[36:39], v[44:47]
    ds_read_b128 a[4:7], v9 offset:2048
    s_waitcnt lgkmcnt(6)
    v_mfma_f32_16x16x32_bf16 v[48:51], a[8:11], a[32:35], v[48:51]
    v_mfma_f32_16x16x32_bf16 v[52:55], a[8:11], a[36:39], v[52:55]
    ds_read_b128 a[8:11], v9 offset:4096
    v_mfma_f32_16x16x32_bf16 v[56:59], a[12:15], a[32:35], v[56:59]
    v_mfma_f32_16x16x32_bf16 v[60:63], a[12:15], a[36:39], v[60:63]
    ds_read_b128 a[12:15], v9 offset:6144
    s_waitcnt lgkmcnt(6)
    v_mfma_f32_16x16x32_bf16 v[64:67], a[16:19], a[32:35], v[64:67]
    v_mfma_f32_16x16x32_bf16 v[68:71], a[16:19], a[36:39], v[68:71]
    ds_read_b128 a[16:19], v9 offset:8192
    v_mfma_f32_16x16x32_bf16 v[72:75], a[20:23], a[32:35], v[72:75]
    v_mfma_f32_16x16x32_bf16 v[76:79], a[20:23], a[36:39], v[76:79]
    ds_read_b128 a[20:23], v9 offset:10240
    s_waitcnt lgkmcnt(6)
    v_mfma_f32_16x16x32_bf16 v[80:83], a[24:27], a[32:35], v[80:83]
    v_mfma_f32_16x16x32_bf16 v[84:87], a[24:27], a[36:39], v[84:87]
    ds_read_b128 a[24:27], v9 offset:12288
    v_mfma_f32_16x16x32_bf16 v[88:91], a[28:31], a[32:35], v[88:91]
    v_mfma_f32_16x16x32_bf16 v[92:95], a[28:31], a[36:39], v[92:95]
    ds_read_b128 a[28:31], v9 offset:14336
    s_waitcnt lgkmcnt(6)
    v_mfma_f32_16x16x32_bf16 v[32:35], a[0:3], a[40:43], v[32:35]
    v_mfma_f32_16x16x32_bf16 v[36:39], a[0:3], a[44:47], v[36:39]
    v_add_u32 v12, 0xc000, v12
    v_add_u32 v10, 0xc000, v10
    v_add_u32 v8, 0xc000, v8
    v_add_u32 v9, 0xc000, v9
    v_mfma_f32_16x16x32_bf16 v[40:43], a[4:7], a[40:43], v[40:43]
    v_mfma_f32_16x16x32_bf16 v[44:47], a[4:7], a[44:47], v[44:47]
    s_waitcnt lgkmcnt(4)
    v_mfma_f32_16x16x32_bf16 v[48:51], a[8:11], a[40:43], v[48:51]
    v_mfma_f32_16x16x32_bf16 v[52:55], a[8:11], a[44:47], v[52:55]
    v_mfma_f32_16x16x32_bf16 v[56:59], a[12:15], a[40:43], v[56:59]
    v_mfma_f32_16x16x32_bf16 v[60:63], a[12:15], a[44:47], v[60:63]
    s_waitcnt lgkmcnt(0)
    s_barrier
    v_mfma_f32_16x16x32_bf16 v[64:67], a[16:19], a[40:43], v[64:67]
    v_mfma_f32_16x16x32_bf16 v[68:71], a[16:19], a[44:47], v[68:71]
    ds_read_b64_tr_b16 a[48:49], v12 offset:0
    ds_read_b64_tr_b16 a[50:51], v12 offset:1024
    ds_read_b64_tr_b16 a[52:53], v10 offset:0
    ds_read_b64_tr_b16 a[54:55], v10 offset:1024
    ds_read_b128 a[0:3], v8 offset:0
    ds_read_b128 a[4:7], v8 offset:2048
    v_mfma_f32_16x16x32_bf16 v[72:75], a[20:23], a[40:43], v[72:75]
    v_mfma_f32_16x16x32_bf16 v[76:79], a[20:23], a[44:47], v[76:79]
    ds_read_b64_tr_b16 a[32:33], v12 offset:8192
    ds_read_b64_tr_b16 a[34:35], v12 offset:9216
    ds_read_b64_tr_b16 a[36:37], v10 offset:8192
    ds_read_b64_tr_b16 a[38:39], v10 offset:9216
    ds_read_b128 a[8:11], v8 offset:4096
    ds_read_b128 a[12:15], v8 offset:6144
    ds_read_b128 a[16:19], v8 offset:8192
    v_mfma_f32_16x16x32_bf16 v[80:83], a[24:27], a[40:43], v[80:83]
    v_mfma_f32_16x16x32_bf16 v[84:87], a[24:27], a[44:47], v[84:87]
    ds_read_b128 a[20:23], v8 offset:10240
    ds_read_b128 a[24:27], v8 offset:12288
    v_mfma_f32_16x16x32_bf16 v[88:91], a[28:31], a[40:43], v[88:91]
    v_mfma_f32_16x16x32_bf16 v[92:95], a[28:31], a[44:47], v[92:95]
    ds_read_b128 a[28:31], v8 offset:14336
    s_waitcnt lgkmcnt(10)
    v_mfma_f32_16x16x32_bf16 v[32:35], a[0:3], a[48:51], v[32:35]
    v_mfma_f32_16x16x32_bf16 v[36:39], a[0:3], a[52:55], v[36:39]
    ds_read_b128 a[0:3], v9 offset:0
    v_mfma_f32_16x16x32_bf16 v[40:43], a[4:7], a[48:51], v[40:43]
    v_mfma_f32_16x16x32_bf16 v[44:47], a[4:7], a[52:55], v[44:47]
    ds_read_b128 a[4:7], v9 offset:2048
    s_waitcnt lgkmcnt(6)
    v_mfma_f32_16x16x32_bf16 v[48:51], a[8:11], a[48:51], v[48:51]
    v_mfma_f32_16x16x32_bf16 v[52:55], a[8:11], a[52:55], v[52:55]
    ds_read_b128 a[8:11], v9 offset:4096
    v_mfma_f32_16x16x32_bf16 v[56:59], a[12:15], a[48:51], v[56:59]
    v_mfma_f32_16x16x32_bf16 v[60:63], a[12:15], a[52:55], v[60:63]
    ds_read_b128 a[12:15], v9 offset:6144
    s_waitcnt lgkmcnt(6)
    v_mfma_f32_16x16x32_bf16 v[64:67], a[16:19], a[48:51], v[64:67]
    v_mfma_f32_16x16x32_bf16 v[68:71], a[16:19], a[52:55], v[68:71]
    ds_read_b128 a[16:19], v9 offset:8192
    v_mfma_f32_16x16x32_bf16 v[72:75], a[20:23], a[48:51], v[72:75]
    v_mfma_f32_16x16x32_bf16 v[76:79], a[20:23], a[52:55], v[76:79]
    ds_read_b128 a[20:23], v9 offset:10240
    s_waitcnt lgkmcnt(6)
    v_mfma_f32_16x16x32_bf16 v[80:83], a[24:27], a[48:51], v[80:83]
    v_mfma_f32_16x16x32_bf16 v[84:87], a[24:27], a[52:55], v[84:87]
    ds_read_b128 a[24:27], v9 offset:12288
    v_mfma_f32_16x16x32_bf16 v[88:91], a[28:31], a[48:51], v[88:91]
    v_mfma_f32_16x16x32_bf16 v[92:95], a[28:31], a[52:55], v[92:95]
    ds_read_b128 a[28:31], v9 offset:14336
    s_waitcnt lgkmcnt(6)
    v_mfma_f32_16x16x32_bf16 v[32:35], a[0:3], a[32:35], v[32:35]
    v_mfma_f32_16x16x32_bf16 v[36:39], a[0:3], a[36:39], v[36:39]
    v_add_u32 v12, 0xc000, v12
    v_add_u32 v10, 0xc000, v10
    v_add_u32 v8, 0xc000, v8
    v_add_u32 v9, 0xc000, v9
    v_mfma_f32_16x16x32_bf16 v[40:43], a[4:7], a[32:35], v[40:43]
    v_mfma_f32_16x16x32_bf16 v[44:47], a[4:7], a[36:39], v[44:47]
    s_waitcnt lgkmcnt(4)
    v_mfma_f32_16x16x32_bf16 v[48:51], a[8:11], a[32:35], v[48:51]
    v_mfma_f32_16x16x32_bf16 v[52:55], a[8:11], a[36:39], v[52:55]
    v_mfma_f32_16x16x32_bf16 v[56:59], a[12:15], a[32:35], v[56:59]
    v_mfma_f32_16x16x32_bf16 v[60:63], a[12:15], a[36:39], v[60:63]
    s_waitcnt lgkmcnt(0)
    s_barrier
    v_mfma_f32_16x16x32_bf16 v[64:67], a[16:19], a[32:35], v[64:67]
    v_mfma_f32_16x16x32_bf16 v[68:71], a[16:19], a[36:39], v[68:71]
    ds_read_b64_tr_b16 a[40:41], v12 offset:0
    ds_read_b64_tr_b16 a[42:43], v12 offset:1024
    ds_read_b64_tr_b16 a[44:45], v10 offset:0
    ds_read_b64_tr_b16 a[46:47], v10 offset:1024
    ds_read_b128 a[0:3], v8 offset:0
    ds_read_b128 a[4:7], v8 offset:2048
    v_mfma_f32_16x16x32_bf16 v[72:75], a[20:23], a[32:35], v[72:75]
    v_mfma_f32_16x16x32_bf16 v[76:79], a[20:23], a[36:39], v[76:79]
    ds_read_b64_tr_b16 a[48:49], v12 offset:8192
    ds_read_b64_tr_b16 a[50:51], v12 offset:9216
    ds_read_b64_tr_b16 a[52:53], v10 offset:8192
    ds_read_b64_tr_b16 a[54:55], v10 offset:9216
    ds_read_b128 a[8:11], v8 offset:4096
    ds_read_b128 a[12:15], v8 offset:6144
    ds_read_b128 a[16:19], v8 offset:8192
    v_mfma_f32_16x16x32_bf16 v[80:83], a[24:27], a[32:35], v[80:83]
    v_mfma_f32_16x16x32_bf16 v[84:87], a[24:27], a[36:39], v[84:87]
    ds_read_b128 a[20:23], v8 offset:10240
    ds_read_b128 a[24:27], v8 offset:12288
    v_mfma_f32_16x16x32_bf16 v[88:91], a[28:31], a[32:35], v[88:91]
    v_mfma_f32_16x16x32_bf16 v[92:95], a[28:31], a[36:39], v[92:95]
    ds_read_b128 a[28:31], v8 offset:14336
    s_waitcnt lgkmcnt(10)
    v_mfma_f32_16x16x32_bf16 v[32:35], a[0:3], a[40:43], v[32:35]
    v_mfma_f32_16x16x32_bf16 v[36:39], a[0:3], a[44:47], v[36:39]
    ds_read_b128 a[0:3], v9 offset:0
    s_add_u32 s89, s72, 0
    buffer_load_dword v0, v21, s[36:39], s89 offen
    v_mfma_f32_16x16x32_bf16 v[40:43], a[4:7], a[40:43], v[40:43]
    v_mfma_f32_16x16x32_bf16 v[44:47], a[4:7], a[44:47], v[44:47]
    ds_read_b128 a[4:7], v9 offset:2048
    s_waitcnt lgkmcnt(6)
    v_mfma_f32_16x16x32_bf16 v[48:51], a[8:11], a[40:43], v[48:51]
    v_mfma_f32_16x16x32_bf16 v[52:55], a[8:11], a[44:47], v[52:55]
    ds_read_b128 a[8:11], v9 offset:4096
    v_mfma_f32_16x16x32_bf16 v[56:59], a[12:15], a[40:43], v[56:59]
    v_mfma_f32_16x16x32_bf16 v[60:63], a[12:15], a[44:47], v[60:63]
    ds_read_b128 a[12:15], v9 offset:6144
    s_waitcnt lgkmcnt(6)
    v_mfma_f32_16x16x32_bf16 v[64:67], a[16:19], a[40:43], v[64:67]
    v_mfma_f32_16x16x32_bf16 v[68:71], a[16:19], a[44:47], v[68:71]
    ds_read_b128 a[16:19], v9 offset:8192
    v_mfma_f32_16x16x32_bf16 v[72:75], a[20:23], a[40:43], v[72:75]
    v_mfma_f32_16x16x32_bf16 v[76:79], a[20:23], a[44:47], v[76:79]
    ds_read_b128 a[20:23], v9 offset:10240
    s_waitcnt lgkmcnt(6)
    v_mfma_f32_16x16x32_bf16 v[80:83], a[24:27], a[40:43], v[80:83]
    v_mfma_f32_16x16x32_bf16 v[84:87], a[24:27], a[44:47], v[84:87]
    ds_read_b128 a[24:27], v9 offset:12288
    v_mfma_f32_16x16x32_bf16 v[88:91], a[28:31], a[40:43], v[88:91]
    v_mfma_f32_16x16x32_bf16 v[92:95], a[28:31], a[44:47], v[92:95]
    ds_read_b128 a[28:31], v9 offset:14336
    s_waitcnt lgkmcnt(6)
    v_mfma_f32_16x16x32_bf16 v[32:35], a[0:3], a[48:51], v[32:35]
    v_mfma_f32_16x16x32_bf16 v[36:39], a[0:3], a[52:55], v[36:39]
    v_add_u32 v12, 0xfffe8000, v12
    v_add_u32 v10, 0xfffe8000, v10
    v_add_u32 v8, 0xfffe8000, v8
    v_add_u32 v9, 0xfffe8000, v9
    v_mfma_f32_16x16x32_bf16 v[40:43], a[4:7], a[48:51], v[40:43]
    v_mfma_f32_16x16x32_bf16 v[44:47], a[4:7], a[52:55], v[44:47]
    s_waitcnt lgkmcnt(4)
    v_mfma_f32_16x16x32_bf16 v[48:51], a[8:11], a[48:51], v[48:51]
    v_mfma_f32_16x16x32_bf16 v[52:55], a[8:11], a[52:55], v[52:55]
    v_mfma_f32_16x16x32_bf16 v[56:59], a[12:15], a[48:51], v[56:59]
    v_mfma_f32_16x16x32_bf16 v[60:63], a[12:15], a[52:55], v[60:63]
    s_waitcnt lgkmcnt(0)
    s_barrier
    v_mfma_f32_16x16x32_bf16 v[64:67], a[16:19], a[48:51], v[64:67]
    v_mfma_f32_16x16x32_bf16 v[68:71], a[16:19], a[52:55], v[68:71]
    ds_read_b64_tr_b16 a[32:33], v12 offset:0
    ds_read_b64_tr_b16 a[34:35], v12 offset:1024
    ds_read_b64_tr_b16 a[36:37], v10 offset:0
    ds_read_b64_tr_b16 a[38:39], v10 offset:1024
    ds_read_b128 a[0:3], v8 offset:0
    ds_read_b128 a[4:7], v8 offset:2048
    v_mfma_f32_16x16x32_bf16 v[72:75], a[20:23], a[48:51], v[72:75]
    v_mfma_f32_16x16x32_bf16 v[76:79], a[20:23], a[52:55], v[76:79]
    ds_read_b64_tr_b16 a[40:41], v12 offset:8192
    ds_read_b64_tr_b16 a[42:43], v12 offset:9216
    ds_read_b64_tr_b16 a[44:45], v10 offset:8192
    ds_read_b64_tr_b16 a[46:47], v10 offset:9216
    ds_read_b128 a[8:11], v8 offset:4096
    ds_read_b128 a[12:15], v8 offset:6144
    ds_read_b128 a[16:19], v8 offset:8192
    v_mfma_f32_16x16x32_bf16 v[80:83], a[24:27], a[48:51], v[80:83]
    v_mfma_f32_16x16x32_bf16 v[84:87], a[24:27], a[52:55], v[84:87]
    ds_read_b128 a[20:23], v8 offset:10240
    ds_read_b128 a[24:27], v8 offset:12288
    v_mfma_f32_16x16x32_bf16 v[88:91], a[28:31], a[48:51], v[88:91]
    v_mfma_f32_16x16x32_bf16 v[92:95], a[28:31], a[52:55], v[92:95]
    ds_read_b128 a[28:31], v8 offset:14336
    s_waitcnt lgkmcnt(10)
    v_mfma_f32_16x16x32_bf16 v[32:35], a[0:3], a[32:35], v[32:35]
    v_mfma_f32_16x16x32_bf16 v[36:39], a[0:3], a[36:39], v[36:39]
    ds_read_b128 a[0:3], v9 offset:0
    s_add_u32 s89, s72, 32768
    buffer_load_dword v0, v21, s[36:39], s89 offen
    v_mfma_f32_16x16x32_bf16 v[40:43], a[4:7], a[32:35], v[40:43]
    v_mfma_f32_16x16x32_bf16 v[44:47], a[4:7], a[36:39], v[44:47]
    ds_read_b128 a[4:7], v9 offset:2048
    s_waitcnt lgkmcnt(6)
    v_mfma_f32_16x16x32_bf16 v[48:51], a[8:11], a[32:35], v[48:51]
    v_mfma_f32_16x16x32_bf16 v[52:55], a[8:11], a[36:39], v[52:55]
    ds_read_b128 a[8:11], v9 offset:4096
    v_mfma_f32_16x16x32_bf16 v[56:59], a[12:15], a[32:35], v[56:59]
    v_mfma_f32_16x16x32_bf16 v[60:63], a[12:15], a[36:39], v[60:63]
    ds_read_b128 a[12:15], v9 offset:6144
    s_waitcnt lgkmcnt(6)
    v_mfma_f32_16x16x32_bf16 v[64:67], a[16:19], a[32:35], v[64:67]
    v_mfma_f32_16x16x32_bf16 v[68:71], a[16:19], a[36:39], v[68:71]
    ds_read_b128 a[16:19], v9 offset:8192
    v_mfma_f32_16x16x32_bf16 v[72:75], a[20:23], a[32:35], v[72:75]
    v_mfma_f32_16x16x32_bf16 v[76:79], a[20:23], a[36:39], v[76:79]
    ds_read_b128 a[20:23], v9 offset:10240
    s_waitcnt lgkmcnt(6)
    v_mfma_f32_16x16x32_bf16 v[80:83], a[24:27], a[32:35], v[80:83]
    v_mfma_f32_16x16x32_bf16 v[84:87], a[24:27], a[36:39], v[84:87]
    ds_read_b128 a[24:27], v9 offset:12288
    v_mfma_f32_16x16x32_bf16 v[88:91], a[28:31], a[32:35], v[88:91]
    v_mfma_f32_16x16x32_bf16 v[92:95], a[28:31], a[36:39], v[92:95]
    ds_read_b128 a[28:31], v9 offset:14336
    s_waitcnt lgkmcnt(6)
    v_mfma_f32_16x16x32_bf16 v[32:35], a[0:3], a[40:43], v[32:35]
    v_mfma_f32_16x16x32_bf16 v[36:39], a[0:3], a[44:47], v[36:39]
    v_add_u32 v12, 0xc000, v12
    v_add_u32 v10, 0xc000, v10
    v_add_u32 v8, 0xc000, v8
    v_add_u32 v9, 0xc000, v9
    v_mfma_f32_16x16x32_bf16 v[40:43], a[4:7], a[40:43], v[40:43]
    v_mfma_f32_16x16x32_bf16 v[44:47], a[4:7], a[44:47], v[44:47]
    s_waitcnt lgkmcnt(4)
    v_mfma_f32_16x16x32_bf16 v[48:51], a[8:11], a[40:43], v[48:51]
    v_mfma_f32_16x16x32_bf16 v[52:55], a[8:11], a[44:47], v[52:55]
    v_mfma_f32_16x16x32_bf16 v[56:59], a[12:15], a[40:43], v[56:59]
    v_mfma_f32_16x16x32_bf16 v[60:63], a[12:15], a[44:47], v[60:63]
    s_waitcnt lgkmcnt(0)
    s_barrier
    v_mfma_f32_16x16x32_bf16 v[64:67], a[16:19], a[40:43], v[64:67]
    v_mfma_f32_16x16x32_bf16 v[68:71], a[16:19], a[44:47], v[68:71]
    ds_read_b64_tr_b16 a[48:49], v12 offset:0
    ds_read_b64_tr_b16 a[50:51], v12 offset:1024
    ds_read_b64_tr_b16 a[52:53], v10 offset:0
    ds_read_b64_tr_b16 a[54:55], v10 offset:1024
    ds_read_b128 a[0:3], v8 offset:0
    ds_read_b128 a[4:7], v8 offset:2048
    v_mfma_f32_16x16x32_bf16 v[72:75], a[20:23], a[40:43], v[72:75]
    v_mfma_f32_16x16x32_bf16 v[76:79], a[20:23], a[44:47], v[76:79]
    ds_read_b64_tr_b16 a[32:33], v12 offset:8192
    ds_read_b64_tr_b16 a[34:35], v12 offset:9216
    ds_read_b64_tr_b16 a[36:37], v10 offset:8192
    ds_read_b64_tr_b16 a[38:39], v10 offset:9216
    ds_read_b128 a[8:11], v8 offset:4096
    ds_read_b128 a[12:15], v8 offset:6144
    ds_read_b128 a[16:19], v8 offset:8192
    v_mfma_f32_16x16x32_bf16 v[80:83], a[24:27], a[40:43], v[80:83]
    v_mfma_f32_16x16x32_bf16 v[84:87], a[24:27], a[44:47], v[84:87]
    ds_read_b128 a[20:23], v8 offset:10240
    ds_read_b128 a[24:27], v8 offset:12288
    v_mfma_f32_16x16x32_bf16 v[88:91], a[28:31], a[40:43], v[88:91]
    v_mfma_f32_16x16x32_bf16 v[92:95], a[28:31], a[44:47], v[92:95]
    ds_read_b128 a[28:31], v8 offset:14336
    s_waitcnt lgkmcnt(10)
    v_mfma_f32_16x16x32_bf16 v[32:35], a[0:3], a[48:51], v[32:35]
    v_mfma_f32_16x16x32_bf16 v[36:39], a[0:3], a[52:55], v[36:39]
    ds_read_b128 a[0:3], v9 offset:0
    v_mov_b32 v23, 155648
    v_mfma_f32_16x16x32_bf16 v[40:43], a[4:7], a[48:51], v[40:43]
    v_mfma_f32_16x16x32_bf16 v[44:47], a[4:7], a[52:55], v[44:47]
    ds_read_b128 a[4:7], v9 offset:2048
    ds_read_b64 v[24:25], v23 offset:0
    s_waitcnt lgkmcnt(7)
    v_mfma_f32_16x16x32_bf16 v[48:51], a[8:11], a[48:51], v[48:51]
    v_mfma_f32_16x16x32_bf16 v[52:55], a[8:11], a[52:55], v[52:55]
    ds_read_b128 a[8:11], v9 offset:4096
    v_mfma_f32_16x16x32_bf16 v[56:59], a[12:15], a[48:51], v[56:59]
    v_mfma_f32_16x16x32_bf16 v[60:63], a[12:15], a[52:55], v[60:63]
    ds_read_b128 a[12:15], v9 offset:6144
    s_waitcnt lgkmcnt(7)
    v_mfma_f32_16x16x32_bf16 v[64:67], a[16:19], a[48:51], v[64:67]
    v_mfma_f32_16x16x32_bf16 v[68:71], a[16:19], a[52:55], v[68:71]
    ds_read_b128 a[16:19], v9 offset:8192
    v_mfma_f32_16x16x32_bf16 v[72:75], a[20:23], a[48:51], v[72:75]
    v_mfma_f32_16x16x32_bf16 v[76:79], a[20:23], a[52:55], v[76:79]
    ds_read_b128 a[20:23], v9 offset:10240
    s_waitcnt lgkmcnt(7)
    v_mfma_f32_16x16x32_bf16 v[80:83], a[24:27], a[48:51], v[80:83]
    v_mfma_f32_16x16x32_bf16 v[84:87], a[24:27], a[52:55], v[84:87]
    ds_read_b128 a[24:27], v9 offset:12288
    s_waitcnt lgkmcnt(5)
    v_readfirstlane_b32 s19, v25
    v_mfma_f32_16x16x32_bf16 v[88:91], a[28:31], a[48:51], v[88:91]
    v_mfma_f32_16x16x32_bf16 v[92:95], a[28:31], a[52:55], v[92:95]
    ds_read_b128 a[28:31], v9 offset:14336
    v_readfirstlane_b32 s97, v24
    v_mfma_f32_16x16x32_bf16 v[32:35], a[0:3], a[32:35], v[32:35]
    v_mfma_f32_16x16x32_bf16 v[36:39], a[0:3], a[36:39], v[36:39]
    v_mfma_f32_16x16x32_bf16 v[40:43], a[4:7], a[32:35], v[40:43]
    v_mfma_f32_16x16x32_bf16 v[44:47], a[4:7], a[36:39], v[44:47]
    v_not_b32 v25, v24
    s_waitcnt lgkmcnt(4)
    v_mfma_f32_16x16x32_bf16 v[48:51], a[8:11], a[32:35], v[48:51]
    v_mfma_f32_16x16x32_bf16 v[52:55], a[8:11], a[36:39], v[52:55]
    v_mfma_f32_16x16x32_bf16 v[56:59], a[12:15], a[32:35], v[56:59]
    v_mfma_f32_16x16x32_bf16 v[60:63], a[12:15], a[36:39], v[60:63]
    s_waitcnt lgkmcnt(0)
    s_barrier
    v_mfma_f32_16x16x32_bf16 v[64:67], a[16:19], a[32:35], v[64:67]
    v_mfma_f32_16x16x32_bf16 v[68:71], a[16:19], a[36:39], v[68:71]
    v_mfma_f32_16x16x32_bf16 v[72:75], a[20:23], a[32:35], v[72:75]
    v_mfma_f32_16x16x32_bf16 v[76:79], a[20:23], a[36:39], v[76:79]
    v_mfma_f32_16x16x32_bf16 v[80:83], a[24:27], a[32:35], v[80:83]
    v_mfma_f32_16x16x32_bf16 v[84:87], a[24:27], a[36:39], v[84:87]
    v_mfma_f32_16x16x32_bf16 v[88:91], a[28:31], a[32:35], v[88:91]
    v_mfma_f32_16x16x32_bf16 v[92:95], a[28:31], a[36:39], v[92:95]
    s_cbranch_vccz L_r_1
    s_setprio 1
L_r_1:
    s_cbranch_vccnz L_r_2
    s_setprio 0
L_r_2:
    ds_read_b64_tr_b16 a[0:1], v6 offset:32768
    ds_read_b64_tr_b16 a[2:3], v6 offset:33792
    v_mul_f32 v36, s83, v36
    v_mul_f32 v37, s83, v37
    v_mul_f32 v38, s83, v38
    v_mul_f32 v39, s83, v39
    v_mul_f32 v44, s83, v44
    v_mul_f32 v45, s83, v45
    ds_read_b64_tr_b16 a[4:5], v6 offset:36864
    ds_read_b64_tr_b16 a[6:7], v6 offset:37888
    v_mul_f32 v46, s83, v46
    v_mul_f32 v47, s83, v47
    v_exp_f32 v36, v36
    v_exp_f32 v37, v37
    v_exp_f32 v38, v38
    v_exp_f32 v39, v39
    ds_read_b64_tr_b16 a[8:9], v6 offset:40960
    ds_read_b64_tr_b16 a[10:11], v6 offset:41984
    v_exp_f32 v44, v44
    v_exp_f32 v45, v45
    v_exp_f32 v46, v46
    v_exp_f32 v47, v47
    v_add_f32 v36, 1.0, v36
    v_add_f32 v37, 1.0, v37
    ds_read_b64_tr_b16 a[12:13], v6 offset:45056
    ds_read_b64_tr_b16 a[14:15], v6 offset:46080
    v_add_f32 v38, 1.0, v38
    v_add_f32 v39, 1.0, v39
    v_add_f32 v44, 1.0, v44
    v_add_f32 v45, 1.0, v45
    v_add_f32 v46, 1.0, v46
    v_add_f32 v47, 1.0, v47
    ds_read_b64_tr_b16 a[16:17], v6 offset:49152
    ds_read_b64_tr_b16 a[18:19], v6 offset:50176
    v_rcp_f32 v36, v36
    v_rcp_f32 v37, v37
    v_rcp_f32 v38, v38
    v_rcp_f32 v39, v39
    v_rcp_f32 v44, v44
    v_rcp_f32 v45, v45
    ds_read_b64_tr_b16 a[20:21], v6 offset:53248
    ds_read_b64_tr_b16 a[22:23], v6 offset:54272
    v_rcp_f32 v46, v46
    v_rcp_f32 v47, v47
    v_mul_f32 v32, v32, v36
    v_mul_f32 v33, v33, v37
    v_mul_f32 v34, v34, v38
    v_mul_f32 v35, v35, v39
    ds_read_b64_tr_b16 a[24:25], v6 offset:57344
    ds_read_b64_tr_b16 a[26:27], v6 offset:58368
    v_mul_f32 v40, v40, v44
    v_mul_f32 v41, v41, v45
    v_mul_f32 v42, v42, v46
    v_mul_f32 v43, v43, v47
    v_cvt_pk_bf16_f32 v26, v32, v33
    v_cvt_pk_bf16_f32 v27, v34, v35
    ds_read_b64_tr_b16 a[28:29], v6 offset:61440
    ds_read_b64_tr_b16 a[30:31], v6 offset:62464
    ds_write_b64 v13, v[26:27] offset:0
    s_cbranch_vccnz L_r_3
    buffer_store_dwordx2 v[26:27], v14, s[32:35], s74 offen sc1
L_r_3:
    s_cbranch_vccz L_r_4
    ds_write_b64 v14, v[26:27] offset:0
    s_waitcnt lgkmcnt(0)
L_r_4:
    v_cvt_pk_bf16_f32 v28, v40, v41
    v_cvt_pk_bf16_f32 v29, v42, v43
    ds_write_b64 v13, v[28:29] offset:32
    s_cbranch_vccnz L_r_5
    s_setprio 1
L_r_5:
    s_cbranch_vccz L_r_6
    s_setprio 0
L_r_6:
    ds_read_b64_tr_b16 a[32:33], v5 offset:0
    ds_read_b64_tr_b16 a[34:35], v5 offset:1024
    v_mul_f32 v52, s83, v52
    v_mul_f32 v53, s83, v53
    v_mul_f32 v54, s83, v54
    v_mul_f32 v55, s83, v55
    v_mul_f32 v60, s83, v60
    v_mul_f32 v61, s83, v61
    ds_read_b64_tr_b16 a[36:37], v5 offset:4096
    ds_read_b64_tr_b16 a[38:39], v5 offset:5120
    v_mul_f32 v62, s83, v62
    v_mul_f32 v63, s83, v63
    v_exp_f32 v52, v52
    v_exp_f32 v53, v53
    v_exp_f32 v54, v54
    v_exp_f32 v55, v55
    ds_read_b64_tr_b16 a[40:41], v5 offset:8192
    ds_read_b64_tr_b16 a[42:43], v5 offset:9216
    v_exp_f32 v60, v60
    v_exp_f32 v61, v61
    v_exp_f32 v62, v62
    v_exp_f32 v63, v63
    v_add_f32 v52, 1.0, v52
    v_add_f32 v53, 1.0, v53
    ds_read_b64_tr_b16 a[44:45], v5 offset:12288
    ds_read_b64_tr_b16 a[46:47], v5 offset:13312
    v_add_f32 v54, 1.0, v54
    v_add_f32 v55, 1.0, v55
    v_add_f32 v60, 1.0, v60
    v_add_f32 v61, 1.0, v61
    v_add_f32 v62, 1.0, v62
    ds_read_b64_tr_b16 a[48:49], v5 offset:16384
    ds_read_b64_tr_b16 a[50:51], v5 offset:17408
    v_add_f32 v63, 1.0, v63
    v_rcp_f32 v52, v52
    v_rcp_f32 v53, v53
    v_rcp_f32 v54, v54
    v_rcp_f32 v55, v55
    v_rcp_f32 v60, v60
    ds_read_b64_tr_b16 a[52:53], v5 offset:20480
    ds_read_b64_tr_b16 a[54:55], v5 offset:21504
    v_rcp_f32 v61, v61
    v_rcp_f32 v62, v62
    v_rcp_f32 v63, v63
    v_mul_f32 v48, v48, v52
    v_mul_f32 v49, v49, v53
    v_mul_f32 v50, v50, v54
    ds_read_b64_tr_b16 a[56:57], v5 offset:24576
    ds_read_b64_tr_b16 a[58:59], v5 offset:25600
    v_mul_f32 v51, v51, v55
    v_mul_f32 v56, v56, v60
    v_mul_f32 v57, v57, v61
    v_mul_f32 v58, v58, v62
    v_mul_f32 v59, v59, v63
    v_cvt_pk_bf16_f32 v26, v48, v49
    ds_read_b64_tr_b16 a[60:61], v5 offset:28672
    ds_read_b64_tr_b16 a[62:63], v5 offset:29696
    v_cvt_pk_bf16_f32 v27, v50, v51
    ds_write_b64 v13, v[26:27] offset:64
    v_cvt_pk_bf16_f32 v28, v56, v57
    v_cvt_pk_bf16_f32 v29, v58, v59
    ds_write_b64 v13, v[28:29] offset:96
    s_cbranch_vccz L_r_7
    s_setprio 1
L_r_7:
    s_cbranch_vccnz L_r_8
    s_setprio 0
L_r_8:
    ds_read_b128 v[32:35], v15 offset:0
    ds_read_b128 v[36:39], v15 offset:16
    ds_read_b128 v[40:43], v15 offset:32
    s_cbranch_vccnz L_r_9
    s_waitcnt vmcnt(0)
    buffer_store_dwordx2 v[24:25], v4, s[32:35], s75 offen sc1
L_r_9:
    s_add_u32 s89, s72, 65536
    buffer_load_dword v0, v21, s[36:39], s89 offen
    s_add_u32 s89, s72, 98304
    buffer_load_dword v0, v21, s[36:39], s89 offen
    v_mul_f32 v68, s83, v68
    v_mul_f32 v69, s83, v69
    v_mul_f32 v70, s83, v70
    v_mul_f32 v71, s83, v71
    v_mul_f32 v76, s83, v76
    v_mul_f32 v77, s83, v77
    v_mul_f32 v78, s83, v78
    v_mul_f32 v79, s83, v79
    v_exp_f32 v68, v68
    v_exp_f32 v69, v69
    v_exp_f32 v70, v70
    v_exp_f32 v71, v71
    v_exp_f32 v76, v76
    v_exp_f32 v77, v77
    v_exp_f32 v78, v78
    v_exp_f32 v79, v79
    s_waitcnt lgkmcnt(2)
    v_mfma_f32_4x4x4_16b_bf16 v[48:51], v[96:97], v[32:33], 0
    v_mfma_f32_4x4x4_16b_bf16 v[52:55], v[96:97], v[34:35], 0
    s_nop 0
    v_mfma_f32_4x4x4_16b_bf16 v[48:51], v[98:99], v[34:35], v[48:51]
    s_waitcnt lgkmcnt(1)
    v_mfma_f32_4x4x4_16b_bf16 v[52:55], v[98:99], v[36:37], v[52:55]
    v_mfma_f32_4x4x4_16b_bf16 v[48:51], v[100:101], v[36:37], v[48:51]
    s_nop 0
    v_mfma_f32_4x4x4_16b_bf16 v[52:55], v[100:101], v[38:39], v[52:55]
    v_mfma_f32_4x4x4_16b_bf16 v[48:51], v[102:103], v[38:39], v[48:51]
    s_waitcnt lgkmcnt(0)
    v_mfma_f32_4x4x4_16b_bf16 v[52:55], v[102:103], v[40:41], v[52:55]
    v_mfma_f32_4x4x4_16b_bf16 v[48:51], v[30:31], v[40:41], v[48:51]
    s_nop 0
    v_mfma_f32_4x4x4_16b_bf16 v[52:55], v[30:31], v[42:43], v[52:55]
    v_add_f32 v68, 1.0, v68
    v_add_f32 v69, 1.0, v69
    v_add_f32 v70, 1.0, v70
    v_add_f32 v71, 1.0, v71
    v_add_f32 v76, 1.0, v76
    v_add_f32 v77, 1.0, v77
    v_add_f32 v78, 1.0, v78
    v_add_f32 v79, 1.0, v79
    s_cbranch_vccnz L_r_10
    s_setprio 1
L_r_10:
    s_cbranch_vccz L_r_11
    s_setprio 0
L_r_11:
    v_rcp_f32 v68, v68
    v_mul_f32 v56, s83, v48
    v_mul_f32 v57, s83, v49
    v_rcp_f32 v69, v69
    v_mul_f32 v58, s83, v50
    v_mul_f32 v59, s83, v51
    v_rcp_f32 v70, v70
    v_mul_f32 v60, s83, v52
    v_mul_f32 v61, s83, v53
    v_rcp_f32 v71, v71
    v_mul_f32 v62, s83, v54
    v_mul_f32 v63, s83, v55
    v_rcp_f32 v76, v76
    v_exp_f32 v56, v56
    v_exp_f32 v57, v57
    v_rcp_f32 v77, v77
    v_exp_f32 v58, v58
    v_exp_f32 v59, v59
    v_rcp_f32 v78, v78
    v_exp_f32 v60, v60
    v_exp_f32 v61, v61
    v_rcp_f32 v79, v79
    v_exp_f32 v62, v62
    v_exp_f32 v63, v63
    v_mul_f32 v64, v64, v68
    v_add_f32 v56, 1.0, v56
    v_add_f32 v57, 1.0, v57
    v_mul_f32 v65, v65, v69
    v_add_f32 v58, 1.0, v58
    v_add_f32 v59, 1.0, v59
    v_mul_f32 v66, v66, v70
    v_add_f32 v60, 1.0, v60
    v_add_f32 v61, 1.0, v61
    s_cbranch_vccz L_r_12
    s_setprio 1
L_r_12:
    s_cbranch_vccnz L_r_13
    s_setprio 0
L_r_13:
    v_mul_f32 v67, v67, v71
    v_add_f32 v62, 1.0, v62
    v_add_f32 v63, 1.0, v63
    v_mul_f32 v72, v72, v76
    v_rcp_f32 v56, v56
    v_rcp_f32 v57, v57
    v_mul_f32 v73, v73, v77
    v_rcp_f32 v58, v58
    v_rcp_f32 v59, v59
    v_mul_f32 v74, v74, v78
    v_rcp_f32 v60, v60
    v_rcp_f32 v61, v61
    v_mul_f32 v75, v75, v79
    v_rcp_f32 v62, v62
    v_rcp_f32 v63, v63
    v_cvt_pk_bf16_f32 v26, v64, v65
    v_mul_f32 v56, v48, v56
    v_mul_f32 v57, v49, v57
    v_cvt_pk_bf16_f32 v27, v66, v67
    v_mul_f32 v58, v50, v58
    v_mul_f32 v59, v51, v59
    ds_write_b64 v13, v[26:27] offset:0
    v_mul_f32 v60, v52, v60
    v_mul_f32 v61, v53, v61
    v_cvt_pk_bf16_f32 v28, v72, v73
    v_mul_f32 v62, v54, v62
    v_mul_f32 v63, v55, v63
    v_cvt_pk_bf16_f32 v29, v74, v75
    v_cvt_pk_bf16_f32 v44, v56, v57
    v_cvt_pk_bf16_f32 v45, v58, v59
    ds_write_b64 v13, v[28:29] offset:32
    v_cvt_pk_bf16_f32 v46, v60, v61
    v_cvt_pk_bf16_f32 v47, v62, v63
    ds_write_b128 v11, v[44:47] offset:0
    ds_read_b64_tr_b16 v[32:33], v20 offset:0
    ds_read_b64_tr_b16 v[34:35], v20 offset:256
    ds_read_b128 v[48:51], v15 offset:64
    ds_read_b128 v[52:55], v16 offset:80
    ds_read_b128 v[56:59], v17 offset:96
    v_mul_f32 v84, s83, v84
    v_mul_f32 v85, s83, v85
    v_mul_f32 v86, s83, v86
    v_mul_f32 v87, s83, v87
    v_mul_f32 v92, s83, v92
    v_mul_f32 v93, s83, v93
    v_mul_f32 v94, s83, v94
    v_mul_f32 v95, s83, v95
    s_add_u32 s89, s72, 0
    s_waitcnt lgkmcnt(3)
    s_nop 0
    s_cmp_eq_u32 s19, 0
    s_cbranch_scc1 L_s_14
    buffer_store_dwordx4 v[32:35], v21, s[36:39], s89 offen
    s_branch L_s_15
L_s_14:
    buffer_store_dwordx4 v[32:35], v21, s[36:39], s89 offen sc1
L_s_15:
    v_exp_f32 v84, v84
    v_exp_f32 v85, v85
    v_exp_f32 v86, v86
    v_exp_f32 v87, v87
    v_exp_f32 v92, v92
    v_exp_f32 v93, v93
    v_exp_f32 v94, v94
    v_exp_f32 v95, v95
    s_barrier
    s_waitcnt lgkmcnt(2)
    v_mfma_f32_4x4x4_16b_bf16 v[36:39], v[96:97], v[48:49], 0
    v_mfma_f32_4x4x4_16b_bf16 v[40:43], v[96:97], v[50:51], 0
    s_nop 0
    v_mfma_f32_4x4x4_16b_bf16 v[36:39], v[98:99], v[50:51], v[36:39]
    s_waitcnt lgkmcnt(1)
    v_mfma_f32_4x4x4_16b_bf16 v[40:43], v[98:99], v[52:53], v[40:43]
    v_mfma_f32_4x4x4_16b_bf16 v[36:39], v[100:101], v[52:53], v[36:39]
    s_nop 0
    v_mfma_f32_4x4x4_16b_bf16 v[40:43], v[100:101], v[54:55], v[40:43]
    v_mfma_f32_4x4x4_16b_bf16 v[36:39], v[102:103], v[54:55], v[36:39]
    s_waitcnt lgkmcnt(0)
    v_mfma_f32_4x4x4_16b_bf16 v[40:43], v[102:103], v[56:57], v[40:43]
    v_mfma_f32_4x4x4_16b_bf16 v[36:39], v[30:31], v[56:57], v[36:39]
    s_nop 0
    v_mfma_f32_4x4x4_16b_bf16 v[40:43], v[30:31], v[58:59], v[40:43]
    v_add_f32 v84, 1.0, v84
    v_add_f32 v85, 1.0, v85
    v_add_f32 v86, 1.0, v86
    v_add_f32 v87, 1.0, v87
    v_add_f32 v92, 1.0, v92
    v_add_f32 v93, 1.0, v93
    v_add_f32 v94, 1.0, v94
    v_add_f32 v95, 1.0, v95
    s_waitcnt vmcnt(0)
    s_nop 0
    s_cmp_eq_u32 s19, 0
    s_cbranch_scc1 L_s_16
    buffer_store_dwordx2 v[24:25], v4, s[32:35], s73 offen
    s_branch L_s_17
L_s_16:
    buffer_store_dwordx2 v[24:25], v4, s[32:35], s73 offen sc1
L_s_17:
    s_cbranch_vccnz L_r_18
    s_setprio 1
L_r_18:
    s_cbranch_vccz L_r_19
    s_setprio 0
L_r_19:
    v_rcp_f32 v84, v84
    v_mul_f32 v60, s83, v36
    v_mul_f32 v61, s83, v37
    v_mul_f32 v62, s83, v38
    v_mul_f32 v63, s83, v39
    v_rcp_f32 v85, v85
    v_mul_f32 v64, s83, v40
    v_mul_f32 v65, s83, v41
    v_mul_f32 v66, s83, v42
    v_mul_f32 v67, s83, v43
    v_rcp_f32 v86, v86
    v_exp_f32 v60, v60
    v_exp_f32 v61, v61
    v_exp_f32 v62, v62
    v_rcp_f32 v87, v87
    v_exp_f32 v63, v63
    v_exp_f32 v64, v64
    v_exp_f32 v65, v65
    v_exp_f32 v66, v66
    v_rcp_f32 v92, v92
    v_exp_f32 v67, v67
    v_add_f32 v60, 1.0, v60
    v_add_f32 v61, 1.0, v61
    v_add_f32 v62, 1.0, v62
    v_rcp_f32 v93, v93
    v_add_f32 v63, 1.0, v63
    v_add_f32 v64, 1.0, v64
    v_add_f32 v65, 1.0, v65
    s_cbranch_vccz L_r_20
    s_setprio 1
L_r_20:
    s_cbranch_vccnz L_r_21
    s_setprio 0
L_r_21:
    v_rcp_f32 v94, v94
    v_add_f32 v66, 1.0, v66
    v_add_f32 v67, 1.0, v67
    v_rcp_f32 v60, v60
    v_rcp_f32 v61, v61
    v_rcp_f32 v95, v95
    v_rcp_f32 v62, v62
    v_rcp_f32 v63, v63
    v_rcp_f32 v64, v64
    v_rcp_f32 v65, v65
    v_mul_f32 v80, v80, v84
    v_rcp_f32 v66, v66
    v_rcp_f32 v67, v67
    v_mul_f32 v60, v36, v60
    v_mul_f32 v81, v81, v85
    v_mul_f32 v61, v37, v61
    v_mul_f32 v62, v38, v62
    v_mul_f32 v63, v39, v63
    v_mul_f32 v64, v40, v64
    v_mul_f32 v82, v82, v86
    v_mul_f32 v65, v41, v65
    v_mul_f32 v66, v42, v66
    v_mul_f32 v67, v43, v67
    v_cvt_pk_bf16_f32 v44, v60, v61
    v_mul_f32 v83, v83, v87
    v_cvt_pk_bf16_f32 v45, v62, v63
    v_cvt_pk_bf16_f32 v46, v64, v65
    v_cvt_pk_bf16_f32 v47, v66, v67
    ds_write_b128 v11, v[44:47] offset:0
    ds_read_b64_tr_b16 v[48:49], v20 offset:0
    ds_read_b64_tr_b16 v[50:51], v20 offset:256
    v_mul_f32 v88, v88, v92
    v_mul_f32 v89, v89, v93
    v_mul_f32 v90, v90, v94
    v_mul_f32 v91, v91, v95
    v_cvt_pk_bf16_f32 v26, v80, v81
    v_cvt_pk_bf16_f32 v27, v82, v83
    ds_write_b64 v13, v[26:27] offset:64
    v_cvt_pk_bf16_f32 v28, v88, v89
    v_cvt_pk_bf16_f32 v29, v90, v91
    ds_write_b64 v13, v[28:29] offset:96
    s_add_u32 s89, s72, 32768
    s_waitcnt lgkmcnt(2)
    s_nop 0
    s_cmp_eq_u32 s19, 0
    s_cbranch_scc1 L_s_22
    buffer_store_dwordx4 v[48:51], v21, s[36:39], s89 offen
    s_branch L_s_23
L_s_22:
    buffer_store_dwordx4 v[48:51], v21, s[36:39], s89 offen sc1
L_s_23:
    s_barrier
    ds_read_b128 v[32:35], v15 offset:0
    ds_read_b128 v[36:39], v15 offset:16
    ds_read_b128 v[40:43], v15 offset:32
    ds_read_b128 v[68:71], v15 offset:64
    ds_read_b128 v[72:75], v18 offset:80
    ds_read_b128 v[76:79], v19 offset:96
    s_waitcnt lgkmcnt(5)
    v_mfma_f32_4x4x4_16b_bf16 v[52:55], v[96:97], v[32:33], 0
    s_waitcnt lgkmcnt(2)
    v_mfma_f32_4x4x4_16b_bf16 v[80:83], v[96:97], v[68:69], 0
    v_mfma_f32_4x4x4_16b_bf16 v[56:59], v[96:97], v[34:35], 0
    v_mfma_f32_4x4x4_16b_bf16 v[84:87], v[96:97], v[70:71], 0
    v_mfma_f32_4x4x4_16b_bf16 v[52:55], v[98:99], v[34:35], v[52:55]
    v_mfma_f32_4x4x4_16b_bf16 v[80:83], v[98:99], v[70:71], v[80:83]
    v_mfma_f32_4x4x4_16b_bf16 v[56:59], v[98:99], v[36:37], v[56:59]
    s_waitcnt lgkmcnt(1)
    v_mfma_f32_4x4x4_16b_bf16 v[84:87], v[98:99], v[72:73], v[84:87]
    v_mfma_f32_4x4x4_16b_bf16 v[52:55], v[100:101], v[36:37], v[52:55]
    v_mfma_f32_4x4x4_16b_bf16 v[80:83], v[100:101], v[72:73], v[80:83]
    v_mfma_f32_4x4x4_16b_bf16 v[56:59], v[100:101], v[38:39], v[56:59]
    v_mfma_f32_4x4x4_16b_bf16 v[84:87], v[100:101], v[74:75], v[84:87]
    v_mfma_f32_4x4x4_16b_bf16 v[52:55], v[102:103], v[38:39], v[52:55]
    v_mfma_f32_4x4x4_16b_bf16 v[80:83], v[102:103], v[74:75], v[80:83]
    v_mfma_f32_4x4x4_16b_bf16 v[56:59], v[102:103], v[40:41], v[56:59]
    s_waitcnt lgkmcnt(0)
    v_mfma_f32_4x4x4_16b_bf16 v[84:87], v[102:103], v[76:77], v[84:87]
    v_mfma_f32_4x4x4_16b_bf16 v[52:55], v[30:31], v[40:41], v[52:55]
    v_mfma_f32_4x4x4_16b_bf16 v[80:83], v[30:31], v[76:77], v[80:83]
    v_mfma_f32_4x4x4_16b_bf16 v[56:59], v[30:31], v[42:43], v[56:59]
    v_mfma_f32_4x4x4_16b_bf16 v[84:87], v[30:31], v[78:79], v[84:87]
    s_nop 1
    v_mul_f32 v60, s83, v52
    v_mul_f32 v61, s83, v53
    v_mul_f32 v62, s83, v54
    v_mul_f32 v63, s83, v55
    v_mul_f32 v64, s83, v56
    v_mul_f32 v65, s83, v57
    v_mul_f32 v66, s83, v58
    v_mul_f32 v67, s83, v59
    s_waitcnt vmcnt(0)
    s_add_u32 s89, s73, 1024
    s_nop 0
    s_cmp_eq_u32 s19, 0
    s_cbranch_scc1 L_s_24
    buffer_store_dwordx2 v[24:25], v4, s[32:35], s89 offen
    s_branch L_s_25
L_s_24:
    buffer_store_dwordx2 v[24:25], v4, s[32:35], s89 offen sc1
L_s_25:
    s_cbranch_vccnz L_r_26
    s_setprio 1
L_r_26:
    s_cbranch_vccz L_r_27
    s_setprio 0
L_r_27:
    v_exp_f32 v60, v60
    v_exp_f32 v61, v61
    v_exp_f32 v62, v62
    v_exp_f32 v63, v63
    v_exp_f32 v64, v64
    v_exp_f32 v65, v65
    v_exp_f32 v66, v66
    v_exp_f32 v67, v67
    v_add_f32 v60, 1.0, v60
    v_add_f32 v61, 1.0, v61
    v_add_f32 v62, 1.0, v62
    v_add_f32 v63, 1.0, v63
    v_add_f32 v64, 1.0, v64
    v_add_f32 v65, 1.0, v65
    v_add_f32 v66, 1.0, v66
    v_add_f32 v67, 1.0, v67
    v_rcp_f32 v60, v60
    v_rcp_f32 v61, v61
    v_rcp_f32 v62, v62
    v_rcp_f32 v63, v63
    v_rcp_f32 v64, v64
    v_rcp_f32 v65, v65
    v_rcp_f32 v66, v66
    v_rcp_f32 v67, v67
    v_mul_f32 v60, v52, v60
    v_mul_f32 v61, v53, v61
    v_mul_f32 v62, v54, v62
    v_mul_f32 v63, v55, v63
    v_mul_f32 v64, v56, v64
    v_mul_f32 v65, v57, v65
    v_mul_f32 v66, v58, v66
    v_mul_f32 v67, v59, v67
    v_cvt_pk_bf16_f32 v44, v60, v61
    v_cvt_pk_bf16_f32 v45, v62, v63
    v_cvt_pk_bf16_f32 v46, v64, v65
    v_cvt_pk_bf16_f32 v47, v66, v67
    ds_write_b128 v11, v[44:47] offset:0
    ds_read_b64_tr_b16 v[32:33], v20 offset:0
    ds_read_b64_tr_b16 v[34:35], v20 offset:256
    v_mul_f32 v88, s83, v80
    v_mul_f32 v89, s83, v81
    v_mul_f32 v90, s83, v82
    v_mul_f32 v91, s83, v83
    v_mul_f32 v92, s83, v84
    v_mul_f32 v93, s83, v85
    v_mul_f32 v94, s83, v86
    v_mul_f32 v95, s83, v87
    v_exp_f32 v88, v88
    v_exp_f32 v89, v89
    v_exp_f32 v90, v90
    v_exp_f32 v91, v91
    v_exp_f32 v92, v92
    v_exp_f32 v93, v93
    v_exp_f32 v94, v94
    v_exp_f32 v95, v95
    s_cbranch_vccz L_r_28
    s_setprio 1
L_r_28:
    s_cbranch_vccnz L_r_29
    s_setprio 0
L_r_29:
    s_add_u32 s89, s72, 65536
    s_waitcnt lgkmcnt(0)
    s_nop 0
    s_cmp_eq_u32 s19, 0
    s_cbranch_scc1 L_s_30
    buffer_store_dwordx4 v[32:35], v21, s[36:39], s89 offen
    s_branch L_s_31
L_s_30:
    buffer_store_dwordx4 v[32:35], v21, s[36:39], s89 offen sc1
L_s_31:
    v_add_f32 v88, 1.0, v88
    v_add_f32 v89, 1.0, v89
    v_add_f32 v90, 1.0, v90
    v_add_f32 v91, 1.0, v91
    v_add_f32 v92, 1.0, v92
    v_add_f32 v93, 1.0, v93
    v_add_f32 v94, 1.0, v94
    v_add_f32 v95, 1.0, v95
    v_rcp_f32 v88, v88
    v_rcp_f32 v89, v89
    v_rcp_f32 v90, v90
    v_rcp_f32 v91, v91
    v_rcp_f32 v92, v92
    v_rcp_f32 v93, v93
    v_rcp_f32 v94, v94
    v_rcp_f32 v95, v95
    v_mul_f32 v88, v80, v88
    v_mul_f32 v89, v81, v89
    v_mul_f32 v90, v82, v90
    v_mul_f32 v91, v83, v91
    v_mul_f32 v92, v84, v92
    v_mul_f32 v93, v85, v93
    v_mul_f32 v94, v86, v94
    v_mul_f32 v95, v87, v95
    v_cvt_pk_bf16_f32 v76, v88, v89
    v_cvt_pk_bf16_f32 v77, v90, v91
    v_cvt_pk_bf16_f32 v78, v92, v93
    v_cvt_pk_bf16_f32 v79, v94, v95
    ds_write_b128 v11, v[76:79] offset:0
    ds_read_b64_tr_b16 v[68:69], v20 offset:0
    ds_read_b64_tr_b16 v[70:71], v20 offset:256
    s_add_u32 s89, s72, 98304
    s_waitcnt lgkmcnt(0)
    s_nop 0
    s_cmp_eq_u32 s19, 0
    s_cbranch_scc1 L_s_32
    buffer_store_dwordx4 v[68:71], v21, s[36:39], s89 offen
    s_branch L_s_33
L_s_32:
    buffer_store_dwordx4 v[68:71], v21, s[36:39], s89 offen sc1
L_s_33:
    ds_read_b64_tr_b16 v[40:41], v5 offset:40960
    ds_read_b64_tr_b16 v[42:43], v5 offset:41984
    ds_read_b64_tr_b16 v[44:45], v5 offset:45056
    ds_read_b64_tr_b16 v[46:47], v5 offset:46080
    ds_read_b64_tr_b16 v[48:49], v5 offset:49152
    ds_read_b64_tr_b16 v[50:51], v5 offset:50176
    ds_read_b64_tr_b16 v[52:53], v5 offset:53248
    ds_read_b64_tr_b16 v[54:55], v5 offset:54272
    ds_read_b64_tr_b16 v[56:57], v5 offset:57344
    ds_read_b64_tr_b16 v[58:59], v5 offset:58368
    ds_read_b64_tr_b16 v[60:61], v5 offset:61440
    ds_read_b64_tr_b16 v[62:63], v5 offset:62464
    ds_read_b64_tr_b16 v[64:65], v6 offset:0
    ds_read_b64_tr_b16 v[66:67], v6 offset:1024
    ds_read_b64_tr_b16 v[72:73], v6 offset:8192
    ds_read_b64_tr_b16 v[74:75], v6 offset:9216
    ds_read_b64_tr_b16 v[76:77], v6 offset:12288
    ds_read_b64_tr_b16 v[78:79], v6 offset:13312
    ds_read_b64_tr_b16 v[80:81], v6 offset:16384
    ds_read_b64_tr_b16 v[82:83], v6 offset:17408
    ds_read_b64_tr_b16 v[84:85], v6 offset:20480
    ds_read_b64_tr_b16 v[86:87], v6 offset:21504
    ds_read_b64_tr_b16 v[88:89], v6 offset:24576
    ds_read_b64_tr_b16 v[90:91], v6 offset:25600
    ds_read_b64_tr_b16 v[92:93], v6 offset:28672
    ds_read_b64_tr_b16 v[94:95], v6 offset:29696
    s_waitcnt vmcnt(1)
    s_add_u32 s89, s73, 2048
    s_nop 0
    s_cmp_eq_u32 s19, 0
    s_cbranch_scc1 L_s_34
    buffer_store_dwordx2 v[24:25], v4, s[32:35], s89 offen
    s_branch L_s_35
L_s_34:
    buffer_store_dwordx2 v[24:25], v4, s[32:35], s89 offen sc1
L_s_35:
    ds_read_b64_tr_b16 v[32:33], v5 offset:32768
    ds_read_b64_tr_b16 v[34:35], v5 offset:33792
    ds_read_b64_tr_b16 v[36:37], v5 offset:36864
    ds_read_b64_tr_b16 v[38:39], v5 offset:37888
    s_waitcnt vmcnt(1)
    s_add_u32 s89, s73, 3072
    s_nop 0
    s_cmp_eq_u32 s19, 0
    s_cbranch_scc1 L_s_36
    buffer_store_dwordx2 v[24:25], v4, s[32:35], s89 offen
    s_branch L_s_37
L_s_36:
    buffer_store_dwordx2 v[24:25], v4, s[32:35], s89 offen sc1
L_s_37:
    ds_read_b64_tr_b16 v[68:69], v6 offset:4096
    ds_read_b64_tr_b16 v[70:71], v6 offset:5120
    s_waitcnt lgkmcnt(0)
    s_barrier
    s_setprio 0
    v_lshlrev_b32 v0, 4, v1
    ds_read_b128 v[8:11], v2 offset:0
    ds_read_b128 v[12:15], v2 offset:1024
    ds_read_b128 v[96:99], v2 offset:2048
    ds_read_b128 v[100:103], v2 offset:3072
    s_waitcnt lgkmcnt(3)
    v_mfma_f32_32x32x16_bf16 v[16:31], a[0:3], v[8:11], 0
    ds_read_b128 v[8:11], v2 offset:4096
    s_waitcnt lgkmcnt(3)
    v_mfma_f32_32x32x16_bf16 v[16:31], a[4:7], v[12:15], v[16:31]
    ds_read_b128 v[12:15], v2 offset:5120
    s_waitcnt lgkmcnt(3)
    v_mfma_f32_32x32x16_bf16 v[16:31], a[8:11], v[96:99], v[16:31]
    ds_read_b128 v[96:99], v2 offset:6144
    s_waitcnt lgkmcnt(3)
    v_mfma_f32_32x32x16_bf16 v[16:31], a[12:15], v[100:103], v[16:31]
    ds_read_b128 v[100:103], v2 offset:7168
    s_waitcnt lgkmcnt(3)
    v_mfma_f32_32x32x16_bf16 v[16:31], a[16:19], v[8:11], v[16:31]
    ds_read_b128 v[8:11], v2 offset:8192
    s_waitcnt lgkmcnt(3)
    v_mfma_f32_32x32x16_bf16 v[16:31], a[20:23], v[12:15], v[16:31]
    ds_read_b128 v[12:15], v2 offset:9216
    s_waitcnt lgkmcnt(3)
    v_mfma_f32_32x32x16_bf16 v[16:31], a[24:27], v[96:99], v[16:31]
    ds_read_b128 v[96:99], v2 offset:10240
    s_waitcnt lgkmcnt(3)
    v_mfma_f32_32x32x16_bf16 v[16:31], a[28:31], v[100:103], v[16:31]
    ds_read_b128 v[100:103], v2 offset:11264
    s_waitcnt lgkmcnt(3)
    v_mfma_f32_32x32x16_bf16 v[16:31], a[32:35], v[8:11], v[16:31]
    ds_read_b128 v[8:11], v2 offset:12288
    s_waitcnt lgkmcnt(3)
    v_mfma_f32_32x32x16_bf16 v[16:31], a[36:39], v[12:15], v[16:31]
    ds_read_b128 v[12:15], v2 offset:13312
    s_waitcnt lgkmcnt(3)
    v_mfma_f32_32x32x16_bf16 v[16:31], a[40:43], v[96:99], v[16:31]
    ds_read_b128 v[96:99], v2 offset:14336
    s_waitcnt lgkmcnt(3)
    v_mfma_f32_32x32x16_bf16 v[16:31], a[44:47], v[100:103], v[16:31]
    ds_read_b128 v[100:103], v2 offset:15360
    s_waitcnt lgkmcnt(3)
    v_mfma_f32_32x32x16_bf16 v[16:31], a[48:51], v[8:11], v[16:31]
    ds_read_b128 v[8:11], v2 offset:16384
    s_waitcnt lgkmcnt(3)
    v_mfma_f32_32x32x16_bf16 v[16:31], a[52:55], v[12:15], v[16:31]
    ds_read_b128 v[12:15], v2 offset:17408
    s_waitcnt lgkmcnt(3)
    v_mfma_f32_32x32x16_bf16 v[16:31], a[56:59], v[96:99], v[16:31]
    ds_read_b128 v[96:99], v2 offset:18432
    s_waitcnt lgkmcnt(3)
    v_mfma_f32_32x32x16_bf16 v[16:31], a[60:63], v[100:103], v[16:31]
    ds_read_b128 v[100:103], v2 offset:19456
    s_waitcnt lgkmcnt(3)
    v_mfma_f32_32x32x16_bf16 v[16:31], v[32:35], v[8:11], v[16:31]
    ds_read_b128 v[8:11], v2 offset:20480
    s_waitcnt lgkmcnt(3)
    v_mfma_f32_32x32x16_bf16 v[16:31], v[36:39], v[12:15], v[16:31]
    ds_read_b128 v[12:15], v2 offset:21504
    s_waitcnt lgkmcnt(3)
    v_mfma_f32_32x32x16_bf16 v[16:31], v[40:43], v[96:99], v[16:31]
    ds_read_b128 v[96:99], v2 offset:22528
    s_waitcnt lgkmcnt(3)
    v_mfma_f32_32x32x16_bf16 v[16:31], v[44:47], v[100:103], v[16:31]
    ds_read_b128 v[100:103], v2 offset:23552
    s_waitcnt lgkmcnt(3)
    v_mfma_f32_32x32x16_bf16 v[16:31], v[48:51], v[8:11], v[16:31]
    ds_read_b128 v[8:11], v2 offset:24576
    s_waitcnt lgkmcnt(3)
    v_mfma_f32_32x32x16_bf16 v[16:31], v[52:55], v[12:15], v[16:31]
    ds_read_b128 v[12:15], v2 offset:25600
    s_waitcnt lgkmcnt(3)
    v_mfma_f32_32x32x16_bf16 v[16:31], v[56:59], v[96:99], v[16:31]
    ds_read_b128 v[96:99], v2 offset:26624
    s_waitcnt lgkmcnt(3)
    v_mfma_f32_32x32x16_bf16 v[16:31], v[60:63], v[100:103], v[16:31]
    ds_read_b128 v[100:103], v2 offset:27648
    s_waitcnt lgkmcnt(3)
    v_mfma_f32_32x32x16_bf16 v[16:31], v[64:67], v[8:11], v[16:31]
    ds_read_b128 v[8:11], v2 offset:28672
    s_waitcnt lgkmcnt(3)
    v_mfma_f32_32x32x16_bf16 v[16:31], v[68:71], v[12:15], v[16:31]
    ds_read_b128 v[12:15], v2 offset:29696
    s_waitcnt lgkmcnt(3)
    v_mfma_f32_32x32x16_bf16 v[16:31], v[72:75], v[96:99], v[16:31]
    ds_read_b128 v[96:99], v2 offset:30720
    s_waitcnt lgkmcnt(3)
    v_mfma_f32_32x32x16_bf16 v[16:31], v[76:79], v[100:103], v[16:31]
    ds_read_b128 v[100:103], v2 offset:31744
    s_waitcnt lgkmcnt(3)
    v_mfma_f32_32x32x16_bf16 v[16:31], v[80:83], v[8:11], v[16:31]
    s_waitcnt lgkmcnt(2)
    v_mfma_f32_32x32x16_bf16 v[16:31], v[84:87], v[12:15], v[16:31]
    s_waitcnt lgkmcnt(1)
    v_mfma_f32_32x32x16_bf16 v[16:31], v[88:91], v[96:99], v[16:31]
    s_waitcnt lgkmcnt(0)
    v_mfma_f32_32x32x16_bf16 v[16:31], v[92:95], v[100:103], v[16:31]
    v_add_u32 v2, s82, v0
    s_nop 10
    v_cvt_pk_bf16_f32 v16, v16, v17
    v_cvt_pk_bf16_f32 v17, v18, v19
    v_cvt_pk_bf16_f32 v18, v20, v21
    v_cvt_pk_bf16_f32 v19, v22, v23
    v_cvt_pk_bf16_f32 v20, v24, v25
    v_cvt_pk_bf16_f32 v21, v26, v27
    v_cvt_pk_bf16_f32 v22, v28, v29
    v_cvt_pk_bf16_f32 v23, v30, v31
    s_barrier
    buffer_store_dwordx4 v[16:19], v3, s[36:39], 0 offen
    buffer_store_dwordx4 v[20:23], v3, s[36:39], 0 offen offset:16
    v_add_u32 v3, 0x10000, v3
    ds_read_b128 v[8:11], v2 offset:0
    ds_read_b128 v[12:15], v2 offset:1024
    ds_read_b128 v[96:99], v2 offset:2048
    ds_read_b128 v[100:103], v2 offset:3072
    s_waitcnt lgkmcnt(3)
    v_mfma_f32_32x32x16_bf16 v[16:31], a[0:3], v[8:11], 0
    ds_read_b128 v[8:11], v2 offset:4096
    s_waitcnt lgkmcnt(3)
    v_mfma_f32_32x32x16_bf16 v[16:31], a[4:7], v[12:15], v[16:31]
    ds_read_b128 v[12:15], v2 offset:5120
    s_waitcnt lgkmcnt(3)
    v_mfma_f32_32x32x16_bf16 v[16:31], a[8:11], v[96:99], v[16:31]
    ds_read_b128 v[96:99], v2 offset:6144
    s_waitcnt lgkmcnt(3)
    v_mfma_f32_32x32x16_bf16 v[16:31], a[12:15], v[100:103], v[16:31]
    ds_read_b128 v[100:103], v2 offset:7168
    s_waitcnt lgkmcnt(3)
    v_mfma_f32_32x32x16_bf16 v[16:31], a[16:19], v[8:11], v[16:31]
    ds_read_b128 v[8:11], v2 offset:8192
    s_waitcnt lgkmcnt(3)
    v_mfma_f32_32x32x16_bf16 v[16:31], a[20:23], v[12:15], v[16:31]
    ds_read_b128 v[12:15], v2 offset:9216
    s_waitcnt lgkmcnt(3)
    v_mfma_f32_32x32x16_bf16 v[16:31], a[24:27], v[96:99], v[16:31]
    ds_read_b128 v[96:99], v2 offset:10240
    s_waitcnt lgkmcnt(3)
    v_mfma_f32_32x32x16_bf16 v[16:31], a[28:31], v[100:103], v[16:31]
    ds_read_b128 v[100:103], v2 offset:11264
    s_waitcnt lgkmcnt(3)
    v_mfma_f32_32x32x16_bf16 v[16:31], a[32:35], v[8:11], v[16:31]
    ds_read_b128 v[8:11], v2 offset:12288
    s_waitcnt lgkmcnt(3)
    v_mfma_f32_32x32x16_bf16 v[16:31], a[36:39], v[12:15], v[16:31]
    ds_read_b128 v[12:15], v2 offset:13312
    s_waitcnt lgkmcnt(3)
    v_mfma_f32_32x32x16_bf16 v[16:31], a[40:43], v[96:99], v[16:31]
    ds_read_b128 v[96:99], v2 offset:14336
    s_waitcnt lgkmcnt(3)
    v_mfma_f32_32x32x16_bf16 v[16:31], a[44:47], v[100:103], v[16:31]
    ds_read_b128 v[100:103], v2 offset:15360
    s_waitcnt lgkmcnt(3)
    v_mfma_f32_32x32x16_bf16 v[16:31], a[48:51], v[8:11], v[16:31]
    ds_read_b128 v[8:11], v2 offset:16384
    s_waitcnt lgkmcnt(3)
    v_mfma_f32_32x32x16_bf16 v[16:31], a[52:55], v[12:15], v[16:31]
    ds_read_b128 v[12:15], v2 offset:17408
    s_waitcnt lgkmcnt(3)
    v_mfma_f32_32x32x16_bf16 v[16:31], a[56:59], v[96:99], v[16:31]
    ds_read_b128 v[96:99], v2 offset:18432
    s_waitcnt lgkmcnt(3)
    v_mfma_f32_32x32x16_bf16 v[16:31], a[60:63], v[100:103], v[16:31]
    ds_read_b128 v[100:103], v2 offset:19456
    s_waitcnt lgkmcnt(3)
    v_mfma_f32_32x32x16_bf16 v[16:31], v[32:35], v[8:11], v[16:31]
    ds_read_b128 v[8:11], v2 offset:20480
    s_waitcnt lgkmcnt(3)
    v_mfma_f32_32x32x16_bf16 v[16:31], v[36:39], v[12:15], v[16:31]
    ds_read_b128 v[12:15], v2 offset:21504
    s_waitcnt lgkmcnt(3)
    v_mfma_f32_32x32x16_bf16 v[16:31], v[40:43], v[96:99], v[16:31]
    ds_read_b128 v[96:99], v2 offset:22528
    s_waitcnt lgkmcnt(3)
    v_mfma_f32_32x32x16_bf16 v[16:31], v[44:47], v[100:103], v[16:31]
    ds_read_b128 v[100:103], v2 offset:23552
    s_waitcnt lgkmcnt(3)
    v_mfma_f32_32x32x16_bf16 v[16:31], v[48:51], v[8:11], v[16:31]
    ds_read_b128 v[8:11], v2 offset:24576
    s_waitcnt lgkmcnt(3)
    v_mfma_f32_32x32x16_bf16 v[16:31], v[52:55], v[12:15], v[16:31]
    ds_read_b128 v[12:15], v2 offset:25600
    s_waitcnt lgkmcnt(3)
    v_mfma_f32_32x32x16_bf16 v[16:31], v[56:59], v[96:99], v[16:31]
    ds_read_b128 v[96:99], v2 offset:26624
    s_waitcnt lgkmcnt(3)
    v_mfma_f32_32x32x16_bf16 v[16:31], v[60:63], v[100:103], v[16:31]
    ds_read_b128 v[100:103], v2 offset:27648
    s_waitcnt lgkmcnt(3)
    v_mfma_f32_32x32x16_bf16 v[16:31], v[64:67], v[8:11], v[16:31]
    ds_read_b128 v[8:11], v2 offset:28672
    s_waitcnt lgkmcnt(3)
    v_mfma_f32_32x32x16_bf16 v[16:31], v[68:71], v[12:15], v[16:31]
    ds_read_b128 v[12:15], v2 offset:29696
    s_waitcnt lgkmcnt(3)
    v_mfma_f32_32x32x16_bf16 v[16:31], v[72:75], v[96:99], v[16:31]
    ds_read_b128 v[96:99], v2 offset:30720
    s_waitcnt lgkmcnt(3)
    v_mfma_f32_32x32x16_bf16 v[16:31], v[76:79], v[100:103], v[16:31]
    ds_read_b128 v[100:103], v2 offset:31744
    s_waitcnt lgkmcnt(3)
    v_mfma_f32_32x32x16_bf16 v[16:31], v[80:83], v[8:11], v[16:31]
    s_waitcnt lgkmcnt(2)
    v_mfma_f32_32x32x16_bf16 v[16:31], v[84:87], v[12:15], v[16:31]
    s_waitcnt lgkmcnt(1)
    v_mfma_f32_32x32x16_bf16 v[16:31], v[88:91], v[96:99], v[16:31]
    s_waitcnt lgkmcnt(0)
    v_mfma_f32_32x32x16_bf16 v[16:31], v[92:95], v[100:103], v[16:31]
    s_nop 11
    v_cvt_pk_bf16_f32 v16, v16, v17
    v_cvt_pk_bf16_f32 v17, v18, v19
    v_cvt_pk_bf16_f32 v18, v20, v21
    v_cvt_pk_bf16_f32 v19, v22, v23
    v_cvt_pk_bf16_f32 v20, v24, v25
    v_cvt_pk_bf16_f32 v21, v26, v27
    v_cvt_pk_bf16_f32 v22, v28, v29
    v_cvt_pk_bf16_f32 v23, v30, v31
    s_barrier
    buffer_store_dwordx4 v[16:19], v3, s[36:39], 0 offen
    buffer_store_dwordx4 v[20:23], v3, s[36:39], 0 offen offset:16
L_end:
    s_endpgm
L_loader:
    s_lshl_b32 s64, s49, 10
    s_lshl_b32 s65, s49, 11
    s_lshl_b32 s82, s49, 12
    s_add_u32 s56, s55, 0
    s_and_b32 s56, s56, 7
    s_lshl_b32 s56, s56, 7
    v_lshrrev_b32 v20, 4, v1
    v_and_b32 v21, 7, v1
    v_lshlrev_b32 v22, 1, v20
    v_xor_b32 v22, v22, v21
    v_lshlrev_b32 v22, 4, v22
    v_bfe_u32 v23, v1, 3, 1
    s_and_b32 s66, s49, 1
    v_xor_b32 v23, s66, v23
    v_lshl_add_u32 v22, v23, 10, v22
    v_lshl_add_u32 v22, v20, 11, v22
    s_lshl_b32 s66, s49, 14
    s_lshl_b32 s67, s52, 7
    s_add_u32 s66, s66, s67
    v_add_u32 v4, s66, v22
    v_lshrrev_b32 v24, 3, v1
    s_lshl_b32 s66, s49, 3
    v_add_u32 v24, s66, v24
    v_bfe_u32 v22, v24, 1, 3
    v_xor_b32 v22, v22, v21
    s_lshl_b32 s66, s53, 8
    s_sub_u32 s66, s66, 7
    v_add_u32 v24, s66, v24
    v_lshlrev_b32 v23, 10, v24
    v_lshl_add_u32 v23, v22, 4, v23
    v_cmp_gt_i32 vcc, 0, v24
    v_mov_b32 v22, 0x80000000
    s_nop 0
    v_cndmask_b32 v3, v23, v22, vcc
    v_add_u32 v2, 0x8000, v23
    s_mov_b32 s26, 1048576
    s_mov_b32 s27, 0x00020000
    s_mov_b32 s22, 4096000
    s_mov_b32 s23, 0x00020000
    s_waitcnt lgkmcnt(0)
    s_mov_b32 s24, s6
    s_mov_b32 s25, s7
    s_add_u32 s20, s4, s3
    s_addc_u32 s21, s5, 0
    s_lshl_b32 s18, s56, 10
    s_add_u32 m0, s65, 0
    s_nop 0
    buffer_load_dwordx4 v4, s[24:27], s18 offen lds
    s_add_u32 s18, s18, 7168
    buffer_load_dwordx4 v4, s[24:27], s18 offen offset:1024 lds
    s_add_u32 m0, s65, 8192
    s_add_u32 s18, s18, 58368
    buffer_load_dwordx4 v4, s[24:27], s18 offen lds
    s_add_u32 s18, s18, 7168
    buffer_load_dwordx4 v4, s[24:27], s18 offen offset:1024 lds
    s_add_u32 m0, s64, 16384
    s_nop 0
    buffer_load_dwordx4 v3, s[20:23], s56 offen lds
    s_add_u32 m0, s64, 32768
    s_add_u32 s18, s56, 98304
    buffer_load_dwordx4 v2, s[20:23], s18 offen lds
    s_add_u32 m0, s64, 20480
    s_nop 0
    buffer_load_dwordx4 v2, s[20:23], s56 offen lds
    s_add_u32 m0, s64, 36864
    s_add_u32 s18, s56, 131072
    buffer_load_dwordx4 v2, s[20:23], s18 offen lds
    s_add_u32 m0, s64, 24576
    s_add_u32 s18, s56, 32768
    buffer_load_dwordx4 v2, s[20:23], s18 offen lds
    s_add_u32 m0, s64, 40960
    s_add_u32 s18, s56, 163840
    buffer_load_dwordx4 v2, s[20:23], s18 offen lds
    s_add_u32 m0, s64, 28672
    s_add_u32 s18, s56, 65536
    buffer_load_dwordx4 v2, s[20:23], s18 offen lds
    s_add_u32 m0, s64, 45056
    s_add_u32 s18, s56, 196608
    buffer_load_dwordx4 v2, s[20:23], s18 offen lds
    s_add_u32 s57, s55, 1
    s_and_b32 s57, s57, 7
    s_lshl_b32 s57, s57, 7
    s_add_u32 s58, s55, 2
    s_and_b32 s58, s58, 7
    s_lshl_b32 s58, s58, 7
    s_add_u32 s59, s55, 3
    s_and_b32 s59, s59, 7
    s_lshl_b32 s59, s59, 7
    s_add_u32 s60, s55, 4
    s_and_b32 s60, s60, 7
    s_lshl_b32 s60, s60, 7
    s_add_u32 s61, s55, 5
    s_and_b32 s61, s61, 7
    s_lshl_b32 s61, s61, 7
    s_add_u32 s62, s55, 6
    s_and_b32 s62, s62, 7
    s_lshl_b32 s62, s62, 7
    s_add_u32 s63, s55, 7
    s_and_b32 s63, s63, 7
    s_lshl_b32 s63, s63, 7
    s_lshl_b32 s18, s57, 10
    s_add_u32 m0, s65, 49152
    s_nop 0
    buffer_load_dwordx4 v4, s[24:27], s18 offen lds
    s_add_u32 s18, s18, 7168
    buffer_load_dwordx4 v4, s[24:27], s18 offen offset:1024 lds
    s_add_u32 m0, s65, 57344
    s_add_u32 s18, s18, 58368
    buffer_load_dwordx4 v4, s[24:27], s18 offen lds
    s_add_u32 s18, s18, 7168
    buffer_load_dwordx4 v4, s[24:27], s18 offen offset:1024 lds
    s_add_u32 m0, s64, 65536
    s_nop 0
    buffer_load_dwordx4 v3, s[20:23], s57 offen lds
    s_add_u32 m0, s64, 81920
    s_add_u32 s18, s57, 98304
    buffer_load_dwordx4 v2, s[20:23], s18 offen lds
    s_add_u32 m0, s64, 69632
    s_nop 0
    buffer_load_dwordx4 v2, s[20:23], s57 offen lds
    s_add_u32 m0, s64, 86016
    s_add_u32 s18, s57, 131072
    buffer_load_dwordx4 v2, s[20:23], s18 offen lds
    s_add_u32 m0, s64, 73728
    s_add_u32 s18, s57, 32768
    buffer_load_dwordx4 v2, s[20:23], s18 offen lds
    s_add_u32 m0, s64, 90112
    s_add_u32 s18, s57, 163840
    buffer_load_dwordx4 v2, s[20:23], s18 offen lds
    s_add_u32 m0, s64, 77824
    s_add_u32 s18, s57, 65536
    buffer_load_dwordx4 v2, s[20:23], s18 offen lds
    s_add_u32 m0, s64, 94208
    s_add_u32 s18, s57, 196608
    buffer_load_dwordx4 v2, s[20:23], s18 offen lds
    s_mov_b32 s32, s16
    s_mov_b32 s33, s17
    s_mov_b32 s34, 16777216
    s_mov_b32 s35, 0x00020000
    s_mov_b32 s44, s14
    s_mov_b32 s45, s15
    s_mov_b32 s46, 256
    s_mov_b32 s47, 0x00020000
    s_add_u32 s36, s12, s3
    s_addc_u32 s37, s13, 0
    s_mov_b32 s38, 4096000
    s_mov_b32 s39, 0x00020000
    s_mov_b32 s28, s10
    s_mov_b32 s29, s11
    s_mov_b32 s30, 524288
    s_mov_b32 s31, 0x00020000
    s_waitcnt vmcnt(12)
    s_barrier
    s_lshl_b32 s18, s58, 10
    s_add_u32 m0, s65, 98304
    s_nop 0
    buffer_load_dwordx4 v4, s[24:27], s18 offen lds
    s_add_u32 s18, s18, 7168
    buffer_load_dwordx4 v4, s[24:27], s18 offen offset:1024 lds
    s_add_u32 m0, s65, 106496
    s_add_u32 s18, s18, 58368
    buffer_load_dwordx4 v4, s[24:27], s18 offen lds
    s_add_u32 s18, s18, 7168
    buffer_load_dwordx4 v4, s[24:27], s18 offen offset:1024 lds
    s_add_u32 m0, s64, 114688
    s_nop 0
    buffer_load_dwordx4 v3, s[20:23], s58 offen lds
    s_add_u32 m0, s64, 131072
    s_add_u32 s18, s58, 98304
    buffer_load_dwordx4 v2, s[20:23], s18 offen lds
    s_add_u32 m0, s64, 118784
    s_nop 0
    buffer_load_dwordx4 v2, s[20:23], s58 offen lds
    s_add_u32 m0, s64, 135168
    s_add_u32 s18, s58, 131072
    buffer_load_dwordx4 v2, s[20:23], s18 offen lds
    s_add_u32 m0, s64, 122880
    s_add_u32 s18, s58, 32768
    buffer_load_dwordx4 v2, s[20:23], s18 offen lds
    s_add_u32 m0, s64, 139264
    s_add_u32 s18, s58, 163840
    buffer_load_dwordx4 v2, s[20:23], s18 offen lds
    s_add_u32 m0, s64, 126976
    s_add_u32 s18, s58, 65536
    buffer_load_dwordx4 v2, s[20:23], s18 offen lds
    s_add_u32 m0, s64, 143360
    s_add_u32 s18, s58, 196608
    buffer_load_dwordx4 v2, s[20:23], s18 offen lds
    v_bfe_u32 v22, v1, 2, 2
    v_xor_b32 v22, v22, v20
    v_and_b32 v23, 3, v1
    v_lshl_add_u32 v22, v22, 2, v23
    v_lshlrev_b32 v22, 4, v22
    v_lshl_add_u32 v22, v20, 10, v22
    s_lshl_b32 s66, s49, 13
    s_lshr_b32 s67, s52, 1
    s_lshl_b32 s67, s67, 8
    s_add_u32 s66, s66, s67
    v_add_u32 v5, s66, v22
    v_mov_b32 v24, 0x80000000
    v_cmp_eq_u32 vcc, 0, v1
    s_nop 1
    v_cndmask_b32 v7, v24, v1, vcc
    v_lshlrev_b32 v9, 4, v1
    v_cmp_gt_u32 vcc, 32, v1
    s_nop 1
    v_cndmask_b32 v10, v24, v9, vcc
    s_add_u32 s67, s55, s49
    s_and_b32 s87, s67, 7
    v_and_b32 v22, 4, v1
    v_xor_b32 v22, s87, v22
    v_lshlrev_b32 v22, 7, v22
    v_lshl_add_u32 v22, v23, 3, v22
    v_cmp_gt_u32 vcc, 8, v1
    s_nop 1
    v_cndmask_b32 v8, v24, v22, vcc
    s_and_b32 s66, s52, 1
    s_lshl_b32 s69, s66, 2
    s_lshl_b32 s68, s51, 3
    s_add_u32 s69, s69, s68
    s_lshl_b32 s79, s69, 10
    s_add_u32 s79, s79, 9437184
    s_and_b32 s69, s69, 127
    s_lshl_b32 s69, s69, 3
    s_add_u32 s78, s69, s87
    s_lshl_b32 s78, s78, 12
    s_lshl_b32 s67, s52, 2
    s_add_u32 s67, s67, s49
    s_lshl_b32 s69, s51, 5
    s_add_u32 s69, s69, s67
    s_add_u32 s69, s69, 32
    s_lshl_b32 s76, s69, 9
    s_add_u32 s76, s76, 8388608
    s_lshl_b32 s77, s69, 7
    s_add_u32 s77, s77, 10485760
    s_cmp_lg_u32 s53, 15
    s_cselect_b32 s80, 1, 0
    buffer_load_dword v12, v7, s[44:47], 0 offen sc1
    s_waitcnt vmcnt(13)
    s_barrier
    s_lshl_b32 s18, s59, 10
    s_add_u32 m0, s65, 0
    s_nop 0
    buffer_load_dwordx4 v4, s[24:27], s18 offen lds
    s_add_u32 s18, s18, 7168
    buffer_load_dwordx4 v4, s[24:27], s18 offen offset:1024 lds
    s_add_u32 m0, s65, 8192
    s_add_u32 s18, s18, 58368
    buffer_load_dwordx4 v4, s[24:27], s18 offen lds
    s_add_u32 s18, s18, 7168
    buffer_load_dwordx4 v4, s[24:27], s18 offen offset:1024 lds
    s_add_u32 m0, s64, 16384
    s_nop 0
    buffer_load_dwordx4 v3, s[20:23], s59 offen lds
    s_add_u32 m0, s64, 32768
    s_add_u32 s18, s59, 98304
    buffer_load_dwordx4 v2, s[20:23], s18 offen lds
    s_add_u32 m0, s64, 20480
    s_nop 0
    buffer_load_dwordx4 v2, s[20:23], s59 offen lds
    s_add_u32 m0, s64, 36864
    s_add_u32 s18, s59, 131072
    buffer_load_dwordx4 v2, s[20:23], s18 offen lds
    s_add_u32 m0, s64, 24576
    s_add_u32 s18, s59, 32768
    buffer_load_dwordx4 v2, s[20:23], s18 offen lds
    s_add_u32 m0, s64, 40960
    s_add_u32 s18, s59, 163840
    buffer_load_dwordx4 v2, s[20:23], s18 offen lds
    s_add_u32 m0, s64, 28672
    s_add_u32 s18, s59, 65536
    buffer_load_dwordx4 v2, s[20:23], s18 offen lds
    s_add_u32 m0, s64, 45056
    s_add_u32 s18, s59, 196608
    buffer_load_dwordx4 v2, s[20:23], s18 offen lds
    s_waitcnt vmcnt(12)
    v_cmp_ne_u32 s[84:85], 0, v12
    s_nop 1
    s_and_b32 s84, s84, 1
    s_cbranch_scc1 L_ok_1001
    s_mov_b32 s81, 0
L_poll_1002:
    s_sleep 4
    buffer_load_dword v12, v7, s[44:47], 0 offen sc1
    s_waitcnt vmcnt(0)
    v_cmp_ne_u32 s[84:85], 0, v12
    s_nop 1
    s_and_b32 s84, s84, 1
    s_cbranch_scc1 L_ok_1001
    s_add_u32 s81, s81, 1
    s_cmp_lt_u32 s81, 262144
    s_cbranch_scc1 L_poll_1002
L_ok_1001:
    s_nop 1
    v_readfirstlane_b32 s70, v12
    s_nop 1
    v_mov_b32 v12, s70
    v_not_b32 v13, s70
    s_getreg_b32 s71, hwreg(HW_REG_XCC_ID, 0, 4)
    s_not_b32 s70, s70
    s_andn2_b32 s70, s70, 15
    s_or_b32 s71, s71, s70
    v_mov_b32 v18, v12
    v_mov_b32 v19, s71
    s_lshl_b32 s66, s51, 10
    s_add_u32 s89, s66, 11010048
    s_lshl_b32 s66, s52, 7
    s_add_u32 s66, s66, s89
    s_cmp_eq_u32 s49, 0
    s_cselect_b32 s66, s66, 16777216
    buffer_store_dwordx2 v[18:19], v7, s[32:35], s66 offen sc1
    v_lshlrev_b32 v17, 7, v1
    v_mov_b32 v24, 0x80000000
    v_cmp_gt_u32 vcc, 8, v1
    s_nop 1
    v_cndmask_b32 v17, v24, v17, vcc
    s_barrier
    s_lshl_b32 s18, s60, 10
    s_add_u32 m0, s65, 49152
    s_nop 0
    buffer_load_dwordx4 v4, s[24:27], s18 offen lds
    s_add_u32 s18, s18, 7168
    buffer_load_dwordx4 v4, s[24:27], s18 offen offset:1024 lds
    s_add_u32 m0, s65, 57344
    s_add_u32 s18, s18, 58368
    buffer_load_dwordx4 v4, s[24:27], s18 offen lds
    s_add_u32 s18, s18, 7168
    buffer_load_dwordx4 v4, s[24:27], s18 offen offset:1024 lds
    s_add_u32 m0, s64, 65536
    s_nop 0
    buffer_load_dwordx4 v3, s[20:23], s60 offen lds
    s_add_u32 m0, s64, 81920
    s_add_u32 s18, s60, 98304
    buffer_load_dwordx4 v2, s[20:23], s18 offen lds
    s_add_u32 m0, s64, 69632
    s_nop 0
    buffer_load_dwordx4 v2, s[20:23], s60 offen lds
    s_add_u32 m0, s64, 86016
    s_add_u32 s18, s60, 131072
    buffer_load_dwordx4 v2, s[20:23], s18 offen lds
    s_add_u32 m0, s64, 73728
    s_add_u32 s18, s60, 32768
    buffer_load_dwordx4 v2, s[20:23], s18 offen lds
    s_add_u32 m0, s64, 90112
    s_add_u32 s18, s60, 163840
    buffer_load_dwordx4 v2, s[20:23], s18 offen lds
    s_add_u32 m0, s64, 77824
    s_add_u32 s18, s60, 65536
    buffer_load_dwordx4 v2, s[20:23], s18 offen lds
    s_add_u32 m0, s64, 94208
    s_add_u32 s18, s60, 196608
    buffer_load_dwordx4 v2, s[20:23], s18 offen lds
    s_waitcnt vmcnt(13)
    s_barrier
    s_lshl_b32 s18, s61, 10
    s_add_u32 m0, s65, 98304
    s_nop 0
    buffer_load_dwordx4 v4, s[24:27], s18 offen lds
    s_add_u32 s18, s18, 7168
    buffer_load_dwordx4 v4, s[24:27], s18 offen offset:1024 lds
    s_add_u32 m0, s65, 106496
    s_add_u32 s18, s18, 58368
    buffer_load_dwordx4 v4, s[24:27], s18 offen lds
    s_add_u32 s18, s18, 7168
    buffer_load_dwordx4 v4, s[24:27], s18 offen offset:1024 lds
    s_add_u32 m0, s64, 114688
    s_nop 0
    buffer_load_dwordx4 v3, s[20:23], s61 offen lds
    s_add_u32 m0, s64, 131072
    s_add_u32 s18, s61, 98304
    buffer_load_dwordx4 v2, s[20:23], s18 offen lds
    s_add_u32 m0, s64, 118784
    s_nop 0
    buffer_load_dwordx4 v2, s[20:23], s61 offen lds
    s_add_u32 m0, s64, 135168
    s_add_u32 s18, s61, 131072
    buffer_load_dwordx4 v2, s[20:23], s18 offen lds
    s_add_u32 m0, s64, 122880
    s_add_u32 s18, s61, 32768
    buffer_load_dwordx4 v2, s[20:23], s18 offen lds
    s_add_u32 m0, s64, 139264
    s_add_u32 s18, s61, 163840
    buffer_load_dwordx4 v2, s[20:23], s18 offen lds
    s_add_u32 m0, s64, 126976
    s_add_u32 s18, s61, 65536
    buffer_load_dwordx4 v2, s[20:23], s18 offen lds
    s_add_u32 m0, s64, 143360
    s_add_u32 s18, s61, 196608
    buffer_load_dwordx4 v2, s[20:23], s18 offen lds
    s_waitcnt vmcnt(12)
    s_barrier
    buffer_load_dwordx2 v[14:15], v17, s[32:35], s89 offen sc1
    s_lshl_b32 s18, s62, 10
    s_add_u32 m0, s65, 0
    s_nop 0
    buffer_load_dwordx4 v4, s[24:27], s18 offen lds
    s_add_u32 s18, s18, 7168
    buffer_load_dwordx4 v4, s[24:27], s18 offen offset:1024 lds
    s_add_u32 m0, s65, 8192
    s_add_u32 s18, s18, 58368
    buffer_load_dwordx4 v4, s[24:27], s18 offen lds
    s_add_u32 s18, s18, 7168
    buffer_load_dwordx4 v4, s[24:27], s18 offen offset:1024 lds
    s_add_u32 m0, s64, 16384
    s_nop 0
    buffer_load_dwordx4 v3, s[20:23], s62 offen lds
    s_add_u32 m0, s64, 32768
    s_add_u32 s18, s62, 98304
    buffer_load_dwordx4 v2, s[20:23], s18 offen lds
    s_add_u32 m0, s64, 20480
    s_nop 0
    buffer_load_dwordx4 v2, s[20:23], s62 offen lds
    s_add_u32 m0, s64, 36864
    s_add_u32 s18, s62, 131072
    buffer_load_dwordx4 v2, s[20:23], s18 offen lds
    s_add_u32 m0, s64, 24576
    s_add_u32 s18, s62, 32768
    buffer_load_dwordx4 v2, s[20:23], s18 offen lds
    s_add_u32 m0, s64, 40960
    s_add_u32 s18, s62, 163840
    buffer_load_dwordx4 v2, s[20:23], s18 offen lds
    s_add_u32 m0, s64, 28672
    s_add_u32 s18, s62, 65536
    buffer_load_dwordx4 v2, s[20:23], s18 offen lds
    s_add_u32 m0, s64, 45056
    s_add_u32 s18, s62, 196608
    buffer_load_dwordx4 v2, s[20:23], s18 offen lds
    s_waitcnt vmcnt(13)
    s_barrier
    s_lshl_b32 s18, s63, 10
    s_add_u32 m0, s65, 49152
    s_nop 0
    buffer_load_dwordx4 v4, s[24:27], s18 offen lds
    s_add_u32 s18, s18, 7168
    buffer_load_dwordx4 v4, s[24:27], s18 offen offset:1024 lds
    s_add_u32 m0, s65, 57344
    s_add_u32 s18, s18, 58368
    buffer_load_dwordx4 v4, s[24:27], s18 offen lds
    s_add_u32 s18, s18, 7168
    buffer_load_dwordx4 v4, s[24:27], s18 offen offset:1024 lds
    s_add_u32 m0, s64, 65536
    s_nop 0
    buffer_load_dwordx4 v3, s[20:23], s63 offen lds
    s_add_u32 m0, s64, 81920
    s_add_u32 s18, s63, 98304
    buffer_load_dwordx4 v2, s[20:23], s18 offen lds
    s_add_u32 m0, s64, 69632
    s_nop 0
    buffer_load_dwordx4 v2, s[20:23], s63 offen lds
    s_add_u32 m0, s64, 86016
    s_add_u32 s18, s63, 131072
    buffer_load_dwordx4 v2, s[20:23], s18 offen lds
    s_add_u32 m0, s64, 73728
    s_add_u32 s18, s63, 32768
    buffer_load_dwordx4 v2, s[20:23], s18 offen lds
    s_add_u32 m0, s64, 90112
    s_add_u32 s18, s63, 163840
    buffer_load_dwordx4 v2, s[20:23], s18 offen lds
    s_add_u32 m0, s64, 77824
    s_add_u32 s18, s63, 65536
    buffer_load_dwordx4 v2, s[20:23], s18 offen lds
    s_add_u32 m0, s64, 94208
    s_add_u32 s18, s63, 196608
    buffer_load_dwordx4 v2, s[20:23], s18 offen lds
    s_waitcnt vmcnt(24)
    v_cmp_eq_u32 s[98:99], v12, v14
    v_and_b32 v21, -16, v15
    v_cmp_eq_u32 s[84:85], s70, v21
    s_nop 1
    s_and_b32 s84, s84, s98
    s_and_b32 s84, s84, 0xff
    s_cmp_eq_u32 s84, 0xff
    s_cbranch_scc1 L_ok_1003
    s_mov_b32 s81, 0
L_poll_1004:
    s_sleep 4
    buffer_load_dwordx2 v[14:15], v17, s[32:35], s89 offen sc1
    s_waitcnt vmcnt(0)
    v_cmp_eq_u32 s[98:99], v12, v14
    v_and_b32 v21, -16, v15
    v_cmp_eq_u32 s[84:85], s70, v21
    s_nop 1
    s_and_b32 s84, s84, s98
    s_and_b32 s84, s84, 0xff
    s_cmp_eq_u32 s84, 0xff
    s_cbranch_scc1 L_ok_1003
    s_add_u32 s81, s81, 1
    s_cmp_lt_u32 s81, 262144
    s_cbranch_scc1 L_poll_1004
L_ok_1003:
    s_nop 1
    v_cmp_eq_u32 s[84:85], s71, v15
    s_nop 1
    s_and_b32 s84, s84, s98
    s_and_b32 s84, s84, 0xff
    s_cmp_eq_u32 s84, 0xff
    s_cselect_b32 s84, 1, 0
    s_mov_b32 s19, s84
    v_mov_b32 v19, s84
    v_mov_b32 v22, 155648
    ds_write_b64 v22, v[18:19] offset:0
    s_waitcnt lgkmcnt(0)
    s_waitcnt vmcnt(12)
    s_barrier
    s_lshl_b32 s18, s56, 9
    s_add_u32 m0, s65, 98304
    s_nop 0
    buffer_load_dwordx4 v5, s[28:31], s18 offen lds
    s_add_u32 s18, s18, 3072
    buffer_load_dwordx4 v5, s[28:31], s18 offen offset:1024 lds
    s_add_u32 m0, s65, 106496
    s_add_u32 s18, s18, 29696
    buffer_load_dwordx4 v5, s[28:31], s18 offen lds
    s_add_u32 s18, s18, 3072
    buffer_load_dwordx4 v5, s[28:31], s18 offen offset:1024 lds
    s_lshl_b32 s18, s57, 9
    s_add_u32 m0, s65, 114688
    s_nop 0
    buffer_load_dwordx4 v5, s[28:31], s18 offen lds
    s_add_u32 s18, s18, 3072
    buffer_load_dwordx4 v5, s[28:31], s18 offen offset:1024 lds
    s_add_u32 m0, s65, 122880
    s_add_u32 s18, s18, 29696
    buffer_load_dwordx4 v5, s[28:31], s18 offen lds
    s_add_u32 s18, s18, 3072
    buffer_load_dwordx4 v5, s[28:31], s18 offen offset:1024 lds
    s_waitcnt vmcnt(8)
    s_barrier
    s_lshl_b32 s18, s58, 9
    s_add_u32 m0, s65, 0
    s_nop 0
    buffer_load_dwordx4 v5, s[28:31], s18 offen lds
    s_add_u32 s18, s18, 3072
    buffer_load_dwordx4 v5, s[28:31], s18 offen offset:1024 lds
    s_add_u32 m0, s65, 8192
    s_add_u32 s18, s18, 29696
    buffer_load_dwordx4 v5, s[28:31], s18 offen lds
    s_add_u32 s18, s18, 3072
    buffer_load_dwordx4 v5, s[28:31], s18 offen offset:1024 lds
    s_lshl_b32 s18, s59, 9
    s_add_u32 m0, s65, 16384
    s_nop 0
    buffer_load_dwordx4 v5, s[28:31], s18 offen lds
    s_add_u32 s18, s18, 3072
    buffer_load_dwordx4 v5, s[28:31], s18 offen offset:1024 lds
    s_add_u32 m0, s65, 24576
    s_add_u32 s18, s18, 29696
    buffer_load_dwordx4 v5, s[28:31], s18 offen lds
    s_add_u32 s18, s18, 3072
    buffer_load_dwordx4 v5, s[28:31], s18 offen offset:1024 lds
    s_lshl_b32 s18, s60, 9
    s_add_u32 m0, s65, 32768
    s_nop 0
    buffer_load_dwordx4 v5, s[28:31], s18 offen lds
    s_add_u32 s18, s18, 3072
    buffer_load_dwordx4 v5, s[28:31], s18 offen offset:1024 lds
    s_add_u32 m0, s65, 40960
    s_add_u32 s18, s18, 29696
    buffer_load_dwordx4 v5, s[28:31], s18 offen lds
    s_add_u32 s18, s18, 3072
    buffer_load_dwordx4 v5, s[28:31], s18 offen offset:1024 lds
    s_waitcnt vmcnt(4)
    s_barrier
    s_lshl_b32 s18, s61, 9
    s_add_u32 m0, s65, 49152
    s_nop 0
    buffer_load_dwordx4 v5, s[28:31], s18 offen lds
    s_add_u32 s18, s18, 3072
    buffer_load_dwordx4 v5, s[28:31], s18 offen offset:1024 lds
    s_add_u32 m0, s65, 57344
    s_add_u32 s18, s18, 29696
    buffer_load_dwordx4 v5, s[28:31], s18 offen lds
    s_add_u32 s18, s18, 3072
    buffer_load_dwordx4 v5, s[28:31], s18 offen offset:1024 lds
    s_lshl_b32 s18, s62, 9
    s_add_u32 m0, s65, 65536
    s_nop 0
    buffer_load_dwordx4 v5, s[28:31], s18 offen lds
    s_add_u32 s18, s18, 3072
    buffer_load_dwordx4 v5, s[28:31], s18 offen offset:1024 lds
    s_add_u32 m0, s65, 73728
    s_add_u32 s18, s18, 29696
    buffer_load_dwordx4 v5, s[28:31], s18 offen lds
    s_add_u32 s18, s18, 3072
    buffer_load_dwordx4 v5, s[28:31], s18 offen offset:1024 lds
    s_lshl_b32 s18, s63, 9
    s_add_u32 m0, s65, 81920
    s_nop 0
    buffer_load_dwordx4 v5, s[28:31], s18 offen lds
    s_add_u32 s18, s18, 3072
    buffer_load_dwordx4 v5, s[28:31], s18 offen offset:1024 lds
    s_add_u32 m0, s65, 90112
    s_add_u32 s18, s18, 29696
    buffer_load_dwordx4 v5, s[28:31], s18 offen lds
    s_add_u32 s18, s18, 3072
    buffer_load_dwordx4 v5, s[28:31], s18 offen offset:1024 lds
    s_waitcnt vmcnt(0)
    s_barrier
    buffer_load_dwordx2 v[14:15], v7, s[32:35], s77 offen sc1
    s_waitcnt vmcnt(0)
    v_cmp_eq_u32 s[98:99], v12, v14
    v_cmp_eq_u32 s[84:85], v13, v15
    s_nop 1
    s_and_b32 s84, s84, s98
    s_and_b32 s84, s84, s80
    s_cmp_eq_u32 s84, s80
    s_cbranch_scc1 L_ok_1005
    s_mov_b32 s81, 0
L_poll_1006:
    s_sleep 4
    buffer_load_dwordx2 v[14:15], v7, s[32:35], s77 offen sc1
    s_waitcnt vmcnt(0)
    v_cmp_eq_u32 s[98:99], v12, v14
    v_cmp_eq_u32 s[84:85], v13, v15
    s_nop 1
    s_and_b32 s84, s84, s98
    s_and_b32 s84, s84, s80
    s_cmp_eq_u32 s84, s80
    s_cbranch_scc1 L_ok_1005
    s_add_u32 s81, s81, 1
    s_cmp_lt_u32 s81, 262144
    s_cbranch_scc1 L_poll_1006
L_ok_1005:
    s_nop 1
    s_add_u32 m0, s64, 159744
    s_nop 0
    buffer_load_dwordx4 v10, s[32:35], s76 offen sc1 lds
    s_waitcnt vmcnt(0)
    s_barrier
    s_add_u32 s88, s79, 0
    buffer_load_dwordx2 v[14:15], v8, s[32:35], s88 offen sc1
    s_waitcnt vmcnt(0)
    v_cmp_eq_u32 s[98:99], v12, v14
    v_cmp_eq_u32 s[84:85], v13, v15
    s_nop 1
    s_and_b32 s84, s84, s98
    s_and_b32 s84, s84, 255
    s_cmp_eq_u32 s84, 255
    s_cbranch_scc1 L_ok_1007
    s_mov_b32 s81, 0
L_poll_1008:
    s_sleep 4
    buffer_load_dwordx2 v[14:15], v8, s[32:35], s88 offen sc1
    s_waitcnt vmcnt(0)
    v_cmp_eq_u32 s[98:99], v12, v14
    v_cmp_eq_u32 s[84:85], v13, v15
    s_nop 1
    s_and_b32 s84, s84, s98
    s_and_b32 s84, s84, 255
    s_cmp_eq_u32 s84, 255
    s_cbranch_scc1 L_ok_1007
    s_add_u32 s81, s81, 1
    s_cmp_lt_u32 s81, 262144
    s_cbranch_scc1 L_poll_1008
L_ok_1007:
    s_nop 1
    s_add_u32 m0, s82, 98304
    s_add_u32 s18, s78, 0
    buffer_load_dwordx4 v9, s[36:39], s18 offen sc1 lds
    buffer_load_dwordx4 v9, s[36:39], s18 offen offset:1024 sc1 lds
    buffer_load_dwordx4 v9, s[36:39], s18 offen offset:2048 sc1 lds
    buffer_load_dwordx4 v9, s[36:39], s18 offen offset:3072 sc1 lds
    s_add_u32 m0, s82, 114688
    s_add_u32 s18, s78, 0
    s_xor_b32 s18, s18, 16384
    buffer_load_dwordx4 v9, s[36:39], s18 offen sc1 lds
    buffer_load_dwordx4 v9, s[36:39], s18 offen offset:1024 sc1 lds
    buffer_load_dwordx4 v9, s[36:39], s18 offen offset:2048 sc1 lds
    buffer_load_dwordx4 v9, s[36:39], s18 offen offset:3072 sc1 lds
    s_add_u32 s88, s79, 1024
    buffer_load_dwordx2 v[14:15], v8, s[32:35], s88 offen sc1
    s_waitcnt vmcnt(0)
    v_cmp_eq_u32 s[98:99], v12, v14
    v_cmp_eq_u32 s[84:85], v13, v15
    s_nop 1
    s_and_b32 s84, s84, s98
    s_and_b32 s84, s84, 255
    s_cmp_eq_u32 s84, 255
    s_cbranch_scc1 L_ok_1009
    s_mov_b32 s81, 0
L_poll_1010:
    s_sleep 4
    buffer_load_dwordx2 v[14:15], v8, s[32:35], s88 offen sc1
    s_waitcnt vmcnt(0)
    v_cmp_eq_u32 s[98:99], v12, v14
    v_cmp_eq_u32 s[84:85], v13, v15
    s_nop 1
    s_and_b32 s84, s84, s98
    s_and_b32 s84, s84, 255
    s_cmp_eq_u32 s84, 255
    s_cbranch_scc1 L_ok_1009
    s_add_u32 s81, s81, 1
    s_cmp_lt_u32 s81, 262144
    s_cbranch_scc1 L_poll_1010
L_ok_1009:
    s_nop 1
    s_add_u32 m0, s82, 0
    s_add_u32 s18, s78, 32768
    buffer_load_dwordx4 v9, s[36:39], s18 offen sc1 lds
    buffer_load_dwordx4 v9, s[36:39], s18 offen offset:1024 sc1 lds
    buffer_load_dwordx4 v9, s[36:39], s18 offen offset:2048 sc1 lds
    buffer_load_dwordx4 v9, s[36:39], s18 offen offset:3072 sc1 lds
    s_add_u32 m0, s82, 16384
    s_add_u32 s18, s78, 32768
    s_xor_b32 s18, s18, 16384
    buffer_load_dwordx4 v9, s[36:39], s18 offen sc1 lds
    buffer_load_dwordx4 v9, s[36:39], s18 offen offset:1024 sc1 lds
    buffer_load_dwordx4 v9, s[36:39], s18 offen offset:2048 sc1 lds
    buffer_load_dwordx4 v9, s[36:39], s18 offen offset:3072 sc1 lds
    s_waitcnt vmcnt(0)
    s_barrier
    v_lshlrev_b32 v21, 1, v17
    v_cmp_gt_u32 vcc, 4, v1
    s_nop 1
    v_cndmask_b32 v21, v24, v21, vcc
    s_lshl_b32 s66, s51, 3
    s_add_u32 s66, s66, s52
    s_lshl_b32 s66, s66, 7
    s_add_u32 s66, s66, 11272192
    s_cmp_eq_u32 s49, 0
    s_cselect_b32 s66, s66, 16777216
    s_cmp_eq_u32 s19, 0
    s_cbranch_scc1 L_s_1011
    buffer_store_dwordx2 v[12:13], v7, s[32:35], s66 offen
    s_branch L_s_1012
L_s_1011:
    buffer_store_dwordx2 v[12:13], v7, s[32:35], s66 offen sc1
L_s_1012:
    s_add_u32 s88, s79, 2048
    buffer_load_dwordx2 v[14:15], v8, s[32:35], s88 offen sc1
    s_waitcnt vmcnt(0)
    v_cmp_eq_u32 s[98:99], v12, v14
    v_cmp_eq_u32 s[84:85], v13, v15
    s_nop 1
    s_and_b32 s84, s84, s98
    s_and_b32 s84, s84, 255
    s_cmp_eq_u32 s84, 255
    s_cbranch_scc1 L_ok_1013
    s_mov_b32 s81, 0
L_poll_1014:
    s_sleep 4
    buffer_load_dwordx2 v[14:15], v8, s[32:35], s88 offen sc1
    s_waitcnt vmcnt(0)
    v_cmp_eq_u32 s[98:99], v12, v14
    v_cmp_eq_u32 s[84:85], v13, v15
    s_nop 1
    s_and_b32 s84, s84, s98
    s_and_b32 s84, s84, 255
    s_cmp_eq_u32 s84, 255
    s_cbranch_scc1 L_ok_1013
    s_add_u32 s81, s81, 1
    s_cmp_lt_u32 s81, 262144
    s_cbranch_scc1 L_poll_1014
L_ok_1013:
    s_nop 1
    s_add_u32 m0, s82, 32768
    s_add_u32 s18, s78, 65536
    buffer_load_dwordx4 v9, s[36:39], s18 offen sc1 lds
    buffer_load_dwordx4 v9, s[36:39], s18 offen offset:1024 sc1 lds
    buffer_load_dwordx4 v9, s[36:39], s18 offen offset:2048 sc1 lds
    buffer_load_dwordx4 v9, s[36:39], s18 offen offset:3072 sc1 lds
    s_add_u32 m0, s82, 49152
    s_add_u32 s18, s78, 65536
    s_xor_b32 s18, s18, 16384
    buffer_load_dwordx4 v9, s[36:39], s18 offen sc1 lds
    buffer_load_dwordx4 v9, s[36:39], s18 offen offset:1024 sc1 lds
    buffer_load_dwordx4 v9, s[36:39], s18 offen offset:2048 sc1 lds
    buffer_load_dwordx4 v9, s[36:39], s18 offen offset:3072 sc1 lds
    s_add_u32 s88, s79, 3072
    buffer_load_dwordx2 v[14:15], v8, s[32:35], s88 offen sc1
    s_waitcnt vmcnt(0)
    v_cmp_eq_u32 s[98:99], v12, v14
    v_cmp_eq_u32 s[84:85], v13, v15
    s_nop 1
    s_and_b32 s84, s84, s98
    s_and_b32 s84, s84, 255
    s_cmp_eq_u32 s84, 255
    s_cbranch_scc1 L_ok_1015
    s_mov_b32 s81, 0
L_poll_1016:
    s_sleep 4
    buffer_load_dwordx2 v[14:15], v8, s[32:35], s88 offen sc1
    s_waitcnt vmcnt(0)
    v_cmp_eq_u32 s[98:99], v12, v14
    v_cmp_eq_u32 s[84:85], v13, v15
    s_nop 1
    s_and_b32 s84, s84, s98
    s_and_b32 s84, s84, 255
    s_cmp_eq_u32 s84, 255
    s_cbranch_scc1 L_ok_1015
    s_add_u32 s81, s81, 1
    s_cmp_lt_u32 s81, 262144
    s_cbranch_scc1 L_poll_1016
L_ok_1015:
    s_nop 1
    s_add_u32 m0, s82, 65536
    s_add_u32 s18, s78, 98304
    buffer_load_dwordx4 v9, s[36:39], s18 offen sc1 lds
    buffer_load_dwordx4 v9, s[36:39], s18 offen offset:1024 sc1 lds
    buffer_load_dwordx4 v9, s[36:39], s18 offen offset:2048 sc1 lds
    buffer_load_dwordx4 v9, s[36:39], s18 offen offset:3072 sc1 lds
    s_add_u32 m0, s82, 81920
    s_add_u32 s18, s78, 98304
    s_xor_b32 s18, s18, 16384
    buffer_load_dwordx4 v9, s[36:39], s18 offen sc1 lds
    buffer_load_dwordx4 v9, s[36:39], s18 offen offset:1024 sc1 lds
    buffer_load_dwordx4 v9, s[36:39], s18 offen offset:2048 sc1 lds
    buffer_load_dwordx4 v9, s[36:39], s18 offen offset:3072 sc1 lds
    s_lshl_b32 s88, s51, 10
    s_and_b32 s66, s52, 1
    s_lshl_b32 s66, s66, 7
    s_add_u32 s88, s88, s66
    s_add_u32 s88, s88, 11272192
    buffer_load_dwordx2 v[14:15], v21, s[32:35], s88 offen sc1
    s_waitcnt vmcnt(0)
    v_cmp_eq_u32 s[98:99], v12, v14
    v_cmp_eq_u32 s[84:85], v13, v15
    s_nop 1
    s_and_b32 s84, s84, s98
    s_and_b32 s84, s84, 15
    s_cmp_eq_u32 s84, 15
    s_cbranch_scc1 L_ok_1017
    s_mov_b32 s81, 0
L_poll_1018:
    s_sleep 4
    buffer_load_dwordx2 v[14:15], v21, s[32:35], s88 offen sc1
    s_waitcnt vmcnt(0)
    v_cmp_eq_u32 s[98:99], v12, v14
    v_cmp_eq_u32 s[84:85], v13, v15
    s_nop 1
    s_and_b32 s84, s84, s98
    s_and_b32 s84, s84, 15
    s_cmp_eq_u32 s84, 15
    s_cbranch_scc1 L_ok_1017
    s_add_u32 s81, s81, 1
    s_cmp_lt_u32 s81, 262144
    s_cbranch_scc1 L_poll_1018
L_ok_1017:
    s_nop 1
    s_barrier
    s_lshl_b32 s66, s51, 3
    s_add_u32 s66, s66, s52
    s_lshl_b32 s66, s66, 7
    s_add_u32 s66, s66, 11272200
    s_cmp_eq_u32 s49, 0
    s_cselect_b32 s66, s66, 16777216
    s_cmp_eq_u32 s19, 0
    s_cbranch_scc1 L_s_1019
    buffer_store_dwordx2 v[12:13], v7, s[32:35], s66 offen
    s_branch L_s_1020
L_s_1019:
    buffer_store_dwordx2 v[12:13], v7, s[32:35], s66 offen sc1
L_s_1020:
    s_lshl_b32 s88, s51, 10
    s_and_b32 s66, s52, 1
    s_lshl_b32 s66, s66, 7
    s_add_u32 s88, s88, s66
    s_add_u32 s88, s88, 11272200
    buffer_load_dwordx2 v[14:15], v21, s[32:35], s88 offen sc1
    s_waitcnt vmcnt(0)
    v_cmp_eq_u32 s[98:99], v12, v14
    v_cmp_eq_u32 s[84:85], v13, v15
    s_nop 1
    s_and_b32 s84, s84, s98
    s_and_b32 s84, s84, 15
    s_cmp_eq_u32 s84, 15
    s_cbranch_scc1 L_ok_1021
    s_mov_b32 s81, 0
L_poll_1022:
    s_sleep 4
    buffer_load_dwordx2 v[14:15], v21, s[32:35], s88 offen sc1
    s_waitcnt vmcnt(0)
    v_cmp_eq_u32 s[98:99], v12, v14
    v_cmp_eq_u32 s[84:85], v13, v15
    s_nop 1
    s_and_b32 s84, s84, s98
    s_and_b32 s84, s84, 15
    s_cmp_eq_u32 s84, 15
    s_cbranch_scc1 L_ok_1021
    s_add_u32 s81, s81, 1
    s_cmp_lt_u32 s81, 262144
    s_cbranch_scc1 L_poll_1022
L_ok_1021:
    s_nop 1
    s_barrier
    s_endpgm

.section .rodata,"a"
.p2align 6
.amdhsa_kernel standalone__conformer_conv_module__speech_kernel
  .amdhsa_next_free_vgpr 168
  .amdhsa_next_free_sgpr 102
  .amdhsa_accum_offset 104
  .amdhsa_group_segment_fixed_size 0
  .amdhsa_kernarg_size 56
  .amdhsa_user_sgpr_count 2
  .amdhsa_user_sgpr_kernarg_segment_ptr 1
  .amdhsa_system_sgpr_workgroup_id_x 1
.end_amdhsa_kernel
```
